```python
import torch

def _softmax(x, axis=-1):
    return torch.softmax(x, dim=axis)
def _gelu(x):
    return torch.nn.functional.gelu(x, approximate="tanh")
def _silu(x):
    return torch.nn.functional.silu(x)
def _sigmoid(x):
    return torch.sigmoid(x)
def _layernorm(x, axis=-1, eps=1e-5):
    m = x.mean(dim=axis, keepdim=True)
    v = x.var(dim=axis, keepdim=True, unbiased=False)
    return (x - m) / torch.sqrt(v + eps)
def _scatter_add(tgt, idx, src, axis=0):
    return tgt.clone().index_add_(axis, idx, src)
def _segment_sum(src, seg, n):
    out = torch.zeros((n,) + src.shape[1:], dtype=src.dtype)
    return out.index_add_(0, seg, src)
def _pad(x, pw):
    flat = tuple(v for pair in reversed(pw) for v in pair)
    return torch.nn.functional.pad(x, flat)

kernel_name = 'gated_mix__mha_block__linear_kernel_hedgehog__prompt'

def setup_inputs():

    _w = (lambda a: (lambda t: t.to(torch.bfloat16) if t.is_floating_point() else t)(torch.as_tensor(a)))
    def _A_setup():
        B, S, D, H = 1, 2048, 512, 32
        return {
            "x": _w((lambda *s: torch.randn(*s, dtype=torch.bfloat16) * 0.05)(B, S, D)),
            "wqkv": _w((lambda *s: torch.randn(*s, dtype=torch.bfloat16) * 0.8)(D, 3 * D)),
            "wo": _w((lambda *s: torch.randn(*s, dtype=torch.bfloat16) * 0.05)(D, D)),
        }
    _A_in = _A_setup()

    def _B_setup():
        B, S, D, H = 1, 2048, 512, 32
        Dh = D // H
        return {
            "x": _w((lambda *s: torch.randn(*s, dtype=torch.bfloat16) * 0.05)(B, S, D)),
            "wqkv": _w((lambda *s: torch.randn(*s, dtype=torch.bfloat16) * 1.6)(D, 3 * D)),
            "w_phi": _w((lambda *s: torch.randn(*s, dtype=torch.bfloat16) * 1.6)(H, Dh, Dh) * (Dh ** -0.5)),
            "wo": _w((lambda *s: torch.randn(*s, dtype=torch.bfloat16) * 0.05)(D, D)),
        }
    _B_in = _B_setup()

    return {
        "A_x": _A_in["x"],
        "A_wqkv": _A_in["wqkv"],
        "A_wo": _A_in["wo"],
        "B_x": _B_in["x"],
        "B_wqkv": _B_in["wqkv"],
        "B_w_phi": _B_in["w_phi"],
        "B_wo": _B_in["wo"],
        "gate_w": _w((lambda *s: torch.randn(*s, dtype=torch.bfloat16) * 0.05)(512) * 16.0),
    }

def reference(A_x, A_wqkv, A_wo, B_x, B_wqkv, B_w_phi, B_wo, gate_w):
    def _A_ref(x, wqkv, wo):
        B, S, D = x.shape
        H = 32
        Dh = D // H
        qkv = (lambda x, *d: x.permute(*d))((x @ wqkv).reshape(B, S, 3, H, Dh), 2, 0, 3, 1, 4)
        q, k, v = qkv[0], qkv[1], qkv[2]
        scores = torch.einsum("bhqd,bhkd->bhqk", q, k) * (Dh ** -0.5)
        p = _softmax(scores, axis=-1)
        o = torch.einsum("bhqk,bhkd->bhqd", p, v)
        return (lambda x, *d: x.permute(*d))(o, 0, 2, 1, 3).reshape(B, S, D) @ wo

    def _B_ref(x, wqkv, w_phi, wo):
        B, S, D = x.shape
        H = 32; Dh = D // H
        qkv = (lambda x, *d: x.permute(*d))((x @ wqkv).reshape(B, S, 3, H, Dh), 2, 0, 3, 1, 4)
        q, k, v = qkv[0], qkv[1], qkv[2]
        pq = torch.einsum("bhsd,hdf->bhsf", q, w_phi)
        pk = torch.einsum("bhsd,hdf->bhsf", k, w_phi)
        phi_q = torch.concatenate([_softmax(pq, axis=-1), _softmax(-pq, axis=-1)], axis=-1)
        phi_k = torch.concatenate([_softmax(pk, axis=-1), _softmax(-pk, axis=-1)], axis=-1)
        kv = torch.einsum("bhsf,bhsd->bhfd", phi_k, v)
        z  = torch.einsum("bhsf->bhf", phi_k)
        num = torch.einsum("bhqf,bhfd->bhqd", phi_q, kv)
        den = torch.einsum("bhqf,bhf->bhq", phi_q, z)[..., None] + 1e-6
        o = num / den
        return (lambda x, *d: x.permute(*d))(o, 0, 2, 1, 3).reshape(B, S, D) @ wo

    x = A_x
    g = _sigmoid((x * gate_w).sum(-1, keepdims=True))
    a = _A_ref(x, A_wqkv, A_wo)
    b = _B_ref(x, B_wqkv, B_w_phi, B_wo)
    return g * a + (1 - g) * b
```

```asm
; @launch grid=(256,1,1) block=(512,1,1) lds=163840
.amdgcn_target "amdgcn-amd-amdhsa--gfx950"
.text
.globl gated_mix__mha_block__linear_kernel_hedgehog__prompt_kernel
.p2align 8
.type gated_mix__mha_block__linear_kernel_hedgehog__prompt_kernel,@function
gated_mix__mha_block__linear_kernel_hedgehog__prompt_kernel:
    s_cmp_ge_u32 s2, 256
    s_cbranch_scc1 L_end
    s_load_dwordx16 s[4:19], s[0:1], 0
    s_load_dwordx4 s[20:23], s[0:1], 64
    s_load_dwordx2 s[24:25], s[0:1], 80
    v_lshrrev_b32 v1, 6, v0
    v_and_b32 v0, 63, v0
    v_readfirstlane_b32 s48, v1
    s_bfe_u32 s51, s2, 0x20003
    s_and_b32 s50, s2, 6
    s_lshl_b32 s50, s50, 1
    s_add_u32 s50, s50, s51
    s_lshl_b32 s51, s51, 1
    s_lshr_b32 s3, s2, 5
    s_add_u32 s51, s51, s3
    s_lshr_b32 s3, s3, 1
    s_and_b32 s49, s2, 1
    s_lshl_b32 s49, s49, 2
    s_add_u32 s49, s49, s3
    s_lshr_b32 s3, s2, 6
    s_and_b32 s26, s2, 7
    s_lshl_b32 s26, s26, 2
    s_add_u32 s26, s26, s3
    s_bfe_u32 s27, s2, 0x30003
    v_mov_b32 v3, 0
    s_cmp_ge_u32 s48, 4
    s_cbranch_scc0 L_compute
    s_sub_u32 s64, s48, 4
    v_lshrrev_b32 v1, 3, v0
    v_and_b32 v2, 7, v0
    v_lshrrev_b32 v8, 4, v0
    v_xor_b32 v9, v2, v8
    v_lshlrev_b32 v10, 10, v1
    v_lshl_add_u32 v4, v9, 4, v10
    v_xor_b32 v5, 64, v4
    v_add_u32 v5, 7168, v5
    v_mul_u32_u24 v10, 3072, v1
    v_and_b32 v8, 1, v8
    v_lshlrev_b32 v8, 2, v8
    v_xor_b32 v9, v2, v8
    v_lshl_add_u32 v6, v9, 4, v10
    v_xor_b32 v7, 32, v6
    v_add_u32 v7, 23552, v7
    s_lshl_b32 s65, s50, 17
    s_lshl_b32 s52, s64, 15
    s_add_u32 s65, s65, s52
    s_mul_i32 s66, s64, 49152
    s_lshl_b32 s52, s49, 7
    s_add_u32 s66, s66, s52
    s_lshl_b32 s67, s64, 12
    s_lshl_b32 s68, s64, 11
    s_mov_b32 s30, 2097152
    s_mov_b32 s31, 0x20000
    s_mov_b32 s34, 1572864
    s_mov_b32 s35, 0x20000
    s_waitcnt lgkmcnt(0)
    s_mov_b32 s28, s4
    s_mov_b32 s29, s5
    s_mov_b32 s32, s6
    s_mov_b32 s33, s7
    s_add_u32 s52, s51, 0
    s_and_b32 s52, s52, 7
    s_lshl_b32 s52, s52, 7
    s_add_u32 m0, s67, 0
    s_add_u32 s52, s52, s65
    buffer_load_dwordx4 v4, s[28:31], s52 offen lds
    buffer_load_dwordx4 v5, s[28:31], s52 offen offset:1024 lds
    s_add_u32 m0, s67, 2048
    s_add_u32 s52, s52, 16384
    buffer_load_dwordx4 v4, s[28:31], s52 offen lds
    buffer_load_dwordx4 v5, s[28:31], s52 offen offset:1024 lds
    s_bitcmp1_b32 s2, 5
    s_cbranch_scc1 L_i1
    s_add_u32 s52, s51, 0
    s_and_b32 s52, s52, 7
    s_mul_i32 s52, s52, 196608
    s_add_u32 s52, s52, s66
    s_xor_b32 s53, s52, 0
    s_add_u32 m0, s68, 131072
    s_add_u32 s53, s53, 1024
    buffer_load_dwordx4 v6, s[32:35], s53 offen lds
    buffer_load_dwordx4 v7, s[32:35], s53 offen offset:1024 lds
    s_xor_b32 s53, s52, 256
    s_add_u32 m0, s68, 139264
    s_add_u32 s53, s53, 2048
    buffer_load_dwordx4 v6, s[32:35], s53 offen lds
    buffer_load_dwordx4 v7, s[32:35], s53 offen offset:1024 lds
    s_branch L_i2
L_i1:
    s_add_u32 s52, s51, 0
    s_and_b32 s52, s52, 7
    s_mul_i32 s52, s52, 196608
    s_add_u32 s52, s52, s66
    s_xor_b32 s53, s52, 128
    s_add_u32 m0, s68, 131072
    s_add_u32 s53, s53, 0
    buffer_load_dwordx4 v6, s[32:35], s53 offen lds
    buffer_load_dwordx4 v7, s[32:35], s53 offen offset:1024 lds
    s_add_u32 s52, s51, 1
    s_and_b32 s52, s52, 7
    s_mul_i32 s52, s52, 196608
    s_add_u32 s52, s52, s66
    s_xor_b32 s53, s52, 128
    s_add_u32 m0, s68, 139264
    s_add_u32 s53, s53, 0
    buffer_load_dwordx4 v6, s[32:35], s53 offen lds
    buffer_load_dwordx4 v7, s[32:35], s53 offen offset:1024 lds
L_i2:
    s_add_u32 s52, s51, 1
    s_and_b32 s52, s52, 7
    s_lshl_b32 s52, s52, 7
    s_add_u32 m0, s67, 16384
    s_add_u32 s52, s52, s65
    buffer_load_dwordx4 v4, s[28:31], s52 offen lds
    buffer_load_dwordx4 v5, s[28:31], s52 offen offset:1024 lds
    s_add_u32 m0, s67, 18432
    s_add_u32 s52, s52, 16384
    buffer_load_dwordx4 v4, s[28:31], s52 offen lds
    buffer_load_dwordx4 v5, s[28:31], s52 offen offset:1024 lds
    s_mov_b32 s36, s12
    s_mov_b32 s37, s13
    s_mov_b32 s38, 0x180000
    s_mov_b32 s39, 0x20000
    s_mov_b32 s40, s24
    s_mov_b32 s41, s25
    s_mov_b32 s42, 0x1322000
    s_mov_b32 s43, 0x20000
    s_cmp_ge_u32 s2, 128
    s_cselect_b32 s12, s16, s8
    s_cselect_b32 s13, s17, s9
    s_mov_b32 s14, 524288
    s_mov_b32 s15, 0x20000
    s_mov_b32 s16, s18
    s_mov_b32 s17, s19
    s_mov_b32 s18, 1024
    s_mov_b32 s19, 0x20000
    s_lshl_b32 s60, s50, 7
    s_lshl_b32 s53, s49, 4
    s_add_u32 s60, s60, s53
    s_bfe_u32 s53, s2, 65541
    s_lshl_b32 s53, s53, 3
    s_add_u32 s60, s60, s53
    s_lshl_b32 s53, s64, 1
    s_add_u32 s60, s60, s53
    s_and_b32 s44, s60, 127
    s_lshl_b32 s60, s60, 2
    s_add_u32 s60, s60, 18874368
    s_bfe_u32 s53, s44, 0x30001
    v_xor_b32 v8, s53, v2
    v_lshlrev_b32 v8, 4, v8
    v_lshl_add_u32 v8, v1, 14, v8
    s_lshl_b32 s44, s44, 7
    v_add_u32 v160, s44, v8
    v_add_u32 v8, s51, v1
    v_and_b32 v8, 7, v8
    v_lshlrev_b32 v8, 7, v8
    v_lshl_add_u32 v161, v2, 4, v8
    v_mov_b32 v157, 0
    v_lshrrev_b32 v8, 2, v0
    v_lshlrev_b32 v8, 10, v8
    v_and_b32 v9, 3, v0
    v_lshl_add_u32 v162, v9, 4, v8
    v_lshrrev_b32 v163, 5, v0
    v_lshlrev_b32 v163, 2, v163
    v_mov_b32 v156, 0
    s_lshl_b32 s52, s2, 2
    s_add_u32 s52, s52, s64
    s_bfe_u32 s53, s52, 0x50004
    s_and_b32 s54, s52, 15
    s_lshl_b32 s45, s53, 14
    s_lshl_b32 s55, s54, 6
    s_add_u32 s45, s45, s55
    s_lshl_b32 s46, s64, 10
    s_add_u32 s46, s46, 159744
    s_lshr_b32 s55, s54, 1
    s_lshl_b32 s61, s55, 17
    s_lshr_b32 s55, s52, 9
    s_lshl_b32 s55, s55, 16
    s_add_u32 s61, s61, s55
    s_lshl_b32 s55, s53, 11
    s_add_u32 s61, s61, s55
    s_and_b32 s55, s54, 1
    s_lshl_b32 s55, s55, 10
    s_add_u32 s61, s61, s55
    s_add_u32 s61, s61, 19005440
    v_bfe_u32 v8, v0, 2, 2
    v_lshlrev_b32 v153, 6, v8
    v_lshrrev_b32 v8, 5, v0
    v_lshl_add_u32 v153, v8, 8, v153
    v_and_b32 v8, 1, v0
    v_lshl_add_u32 v153, v8, 5, v153
    v_bfe_u32 v8, v0, 4, 1
    v_lshl_add_u32 v153, v8, 4, v153
    v_bfe_u32 v8, v0, 1, 1
    v_lshl_add_u32 v153, v8, 3, v153
    v_add_u32 v153, s46, v153
    s_mov_b32 s3, 0
    s_and_b32 s52, s48, 3
    s_lshl_b32 s53, s27, 3
    s_lshl_b32 s54, s52, 1
    s_add_u32 s53, s53, s54
    s_add_u32 s53, s53, 0
    s_lshl_b32 s4, s53, 5
    s_add_u32 s4, s4, s26
    s_lshl_b32 s4, s4, 10
    s_add_u32 s4, s4, 14680064
    s_lshl_b32 s8, s26, 6
    s_add_u32 s8, s8, s53
    s_lshl_b32 s8, s8, 11
    s_add_u32 s8, s8, 6291456
    s_lshr_b32 s5, s26, 2
    s_xor_b32 s5, s5, 4
    s_lshl_b32 s5, s5, 8
    s_add_u32 s5, s5, 20054016
    s_lshl_b32 s6, s26, 17
    s_lshl_b32 s54, s52, 10
    s_add_u32 s6, s6, s54
    s_lshl_b32 s54, s27, 7
    s_add_u32 s6, s6, s54
    s_add_u32 s6, s6, 10485760
    s_lshl_b32 s7, s26, 11
    s_add_u32 s7, s7, 18939904
    s_lshr_b32 s9, s2, 5
    s_lshl_b32 s9, s9, 17
    s_add_u32 s9, s9, 19005440
    s_lshr_b32 s53, s48, 1
    s_lshl_b32 s10, s53, 14
    s_add_u32 s10, s10, s9
    s_add_u32 s10, s10, 65536
    s_lshl_b32 s54, s48, 13
    s_add_u32 s9, s9, s54
    s_and_b32 s11, s2, 31
    s_lshl_b32 s11, s11, 1
    s_and_b32 s54, s48, 1
    s_add_u32 s11, s11, s54
    s_lshl_b32 s0, s11, 7
    s_add_u32 s0, s0, 18874368
    s_lshl_b32 s11, s11, 5
    s_lshl_b32 s53, s53, 3
    s_add_u32 s11, s11, s53
    s_lshl_b32 s11, s11, 10
    s_add_u32 s11, s11, 14680064
    s_lshl_b32 s1, s52, 13
    s_add_u32 s1, s1, 69632
    v_mov_b32 v36, 0xdddddddd
    v_and_b32 v39, 27, v0
    v_cmp_eq_u32 vcc, 16, v39
    v_mov_b32 v38, 0x3f803f80
    v_mov_b64 v[44:45], -1
    v_cndmask_b32 v38, 0, v38, vcc
    v_mov_b64 v[46:47], -1
    v_mov_b32 v39, v38
    v_mov_b64 v[20:21], v[38:39]
    v_mov_b64 v[22:23], v[38:39]
    v_mov_b64 v[24:25], v[38:39]
    v_mov_b64 v[26:27], v[38:39]
    v_mov_b64 v[28:29], v[38:39]
    v_mov_b64 v[30:31], v[38:39]
    v_mov_b64 v[32:33], v[38:39]
    v_mov_b64 v[34:35], v[38:39]
    v_mov_b64 v[112:113], 0
    v_mov_b64 v[114:115], 0
    v_mov_b64 v[116:117], 0
    v_mov_b64 v[118:119], 0
    v_mov_b64 v[120:121], 0
    v_mov_b64 v[122:123], 0
    v_mov_b64 v[124:125], 0
    v_mov_b64 v[126:127], 0
    v_mov_b64 v[128:129], 0
    v_mov_b64 v[130:131], 0
    v_mov_b64 v[132:133], 0
    v_mov_b64 v[134:135], 0
    v_mov_b64 v[136:137], 0
    v_mov_b64 v[138:139], 0
    v_mov_b64 v[140:141], 0
    v_mov_b64 v[142:143], 0
    v_lshlrev_b32 v42, 12, v1
    v_lshl_add_u32 v42, v2, 4, v42
    s_lshl_b32 s52, s27, 7
    s_lshr_b32 s53, s64, 1
    s_lshl_b32 s53, s53, 10
    s_add_u32 s52, s52, s53
    s_and_b32 s53, s64, 1
    s_lshl_b32 s53, s53, 3
    s_add_u32 s52, s52, s53
    v_lshlrev_b32 v43, 4, v2
    v_bfe_u32 v8, v0, 4, 1
    v_lshl_add_u32 v43, v8, 2, v43
    v_add_u32 v43, s52, v43
    v_lshlrev_b32 v1, 4, v0
    v_mov_b32 v37, v1
    s_lshl_b32 s52, s64, 9
    s_add_u32 s52, s52, 53248
    v_lshrrev_b32 v155, 1, v1
    v_add_u32 v155, s52, v155
    s_bitcmp1_b32 s2, 5
    s_cbranch_scc1 L_ld1
L_ld0:
    s_add_u32 s52, s51, 1
    s_and_b32 s52, s52, 7
    s_mul_i32 s52, s52, 196608
    s_add_u32 s52, s52, s66
    s_xor_b32 s53, s52, 0
    s_add_u32 m0, s68, 147456
    s_add_u32 s53, s53, 1024
    buffer_load_dwordx4 v6, s[32:35], s53 offen lds
    buffer_load_dwordx4 v7, s[32:35], s53 offen offset:1024 lds
    s_xor_b32 s53, s52, 256
    s_add_u32 m0, s68, 155648
    s_add_u32 s53, s53, 2048
    buffer_load_dwordx4 v6, s[32:35], s53 offen lds
    buffer_load_dwordx4 v7, s[32:35], s53 offen offset:1024 lds
    s_waitcnt vmcnt(8)
    s_barrier
    s_add_u32 s52, s51, 2
    s_and_b32 s52, s52, 7
    s_mul_i32 s52, s52, 196608
    s_add_u32 s52, s52, s66
    s_xor_b32 s53, s52, 0
    s_add_u32 m0, s68, 114688
    s_add_u32 s53, s53, 1024
    buffer_load_dwordx4 v6, s[32:35], s53 offen lds
    buffer_load_dwordx4 v7, s[32:35], s53 offen offset:1024 lds
    s_xor_b32 s53, s52, 256
    s_add_u32 m0, s68, 122880
    s_add_u32 s53, s53, 2048
    buffer_load_dwordx4 v6, s[32:35], s53 offen lds
    buffer_load_dwordx4 v7, s[32:35], s53 offen offset:1024 lds
    s_add_u32 s52, s51, 2
    s_and_b32 s52, s52, 7
    s_lshl_b32 s52, s52, 7
    s_add_u32 m0, s67, 32768
    s_add_u32 s52, s52, s65
    buffer_load_dwordx4 v4, s[28:31], s52 offen lds
    buffer_load_dwordx4 v5, s[28:31], s52 offen offset:1024 lds
    s_add_u32 m0, s67, 34816
    s_add_u32 s52, s52, 16384
    buffer_load_dwordx4 v4, s[28:31], s52 offen lds
    buffer_load_dwordx4 v5, s[28:31], s52 offen offset:1024 lds
    s_waitcnt vmcnt(8)
    s_barrier
    s_add_u32 s52, s51, 3
    s_and_b32 s52, s52, 7
    s_mul_i32 s52, s52, 196608
    s_add_u32 s52, s52, s66
    s_xor_b32 s53, s52, 0
    s_add_u32 m0, s68, 131072
    s_add_u32 s53, s53, 1024
    buffer_load_dwordx4 v6, s[32:35], s53 offen lds
    buffer_load_dwordx4 v7, s[32:35], s53 offen offset:1024 lds
    s_xor_b32 s53, s52, 256
    s_add_u32 m0, s68, 139264
    s_add_u32 s53, s53, 2048
    buffer_load_dwordx4 v6, s[32:35], s53 offen lds
    buffer_load_dwordx4 v7, s[32:35], s53 offen offset:1024 lds
    s_add_u32 s52, s51, 3
    s_and_b32 s52, s52, 7
    s_lshl_b32 s52, s52, 7
    s_add_u32 m0, s67, 49152
    s_add_u32 s52, s52, s65
    buffer_load_dwordx4 v4, s[28:31], s52 offen lds
    buffer_load_dwordx4 v5, s[28:31], s52 offen offset:1024 lds
    s_add_u32 m0, s67, 51200
    s_add_u32 s52, s52, 16384
    buffer_load_dwordx4 v4, s[28:31], s52 offen lds
    buffer_load_dwordx4 v5, s[28:31], s52 offen offset:1024 lds
    s_waitcnt vmcnt(8)
    s_barrier
    s_add_u32 s52, s51, 4
    s_and_b32 s52, s52, 7
    s_mul_i32 s52, s52, 196608
    s_add_u32 s52, s52, s66
    s_xor_b32 s53, s52, 0
    s_add_u32 m0, s68, 147456
    s_add_u32 s53, s53, 1024
    buffer_load_dwordx4 v6, s[32:35], s53 offen lds
    buffer_load_dwordx4 v7, s[32:35], s53 offen offset:1024 lds
    s_xor_b32 s53, s52, 256
    s_add_u32 m0, s68, 155648
    s_add_u32 s53, s53, 2048
    buffer_load_dwordx4 v6, s[32:35], s53 offen lds
    buffer_load_dwordx4 v7, s[32:35], s53 offen offset:1024 lds
    s_add_u32 s52, s51, 4
    s_and_b32 s52, s52, 7
    s_lshl_b32 s52, s52, 7
    s_add_u32 m0, s67, 65536
    s_add_u32 s52, s52, s65
    buffer_load_dwordx4 v4, s[28:31], s52 offen lds
    buffer_load_dwordx4 v5, s[28:31], s52 offen offset:1024 lds
    s_add_u32 m0, s67, 67584
    s_add_u32 s52, s52, 16384
    buffer_load_dwordx4 v4, s[28:31], s52 offen lds
    buffer_load_dwordx4 v5, s[28:31], s52 offen offset:1024 lds
    s_waitcnt vmcnt(8)
    s_barrier
    s_add_u32 s52, s51, 5
    s_and_b32 s52, s52, 7
    s_mul_i32 s52, s52, 196608
    s_add_u32 s52, s52, s66
    s_xor_b32 s53, s52, 0
    s_add_u32 m0, s68, 114688
    s_add_u32 s53, s53, 1024
    buffer_load_dwordx4 v6, s[32:35], s53 offen lds
    buffer_load_dwordx4 v7, s[32:35], s53 offen offset:1024 lds
    s_xor_b32 s53, s52, 256
    s_add_u32 m0, s68, 122880
    s_add_u32 s53, s53, 2048
    buffer_load_dwordx4 v6, s[32:35], s53 offen lds
    buffer_load_dwordx4 v7, s[32:35], s53 offen offset:1024 lds
    s_add_u32 s52, s51, 5
    s_and_b32 s52, s52, 7
    s_lshl_b32 s52, s52, 7
    s_add_u32 m0, s67, 81920
    s_add_u32 s52, s52, s65
    buffer_load_dwordx4 v4, s[28:31], s52 offen lds
    buffer_load_dwordx4 v5, s[28:31], s52 offen offset:1024 lds
    s_add_u32 m0, s67, 83968
    s_add_u32 s52, s52, 16384
    buffer_load_dwordx4 v4, s[28:31], s52 offen lds
    buffer_load_dwordx4 v5, s[28:31], s52 offen offset:1024 lds
    s_waitcnt vmcnt(8)
    s_barrier
    s_add_u32 s52, s51, 6
    s_and_b32 s52, s52, 7
    s_mul_i32 s52, s52, 196608
    s_add_u32 s52, s52, s66
    s_xor_b32 s53, s52, 0
    s_add_u32 m0, s68, 131072
    s_add_u32 s53, s53, 1024
    buffer_load_dwordx4 v6, s[32:35], s53 offen lds
    buffer_load_dwordx4 v7, s[32:35], s53 offen offset:1024 lds
    s_xor_b32 s53, s52, 256
    s_add_u32 m0, s68, 139264
    s_add_u32 s53, s53, 2048
    buffer_load_dwordx4 v6, s[32:35], s53 offen lds
    buffer_load_dwordx4 v7, s[32:35], s53 offen offset:1024 lds
    s_add_u32 s52, s51, 6
    s_and_b32 s52, s52, 7
    s_lshl_b32 s52, s52, 7
    s_add_u32 m0, s67, 98304
    s_add_u32 s52, s52, s65
    buffer_load_dwordx4 v4, s[28:31], s52 offen lds
    buffer_load_dwordx4 v5, s[28:31], s52 offen offset:1024 lds
    s_add_u32 m0, s67, 100352
    s_add_u32 s52, s52, 16384
    buffer_load_dwordx4 v4, s[28:31], s52 offen lds
    buffer_load_dwordx4 v5, s[28:31], s52 offen offset:1024 lds
    s_waitcnt vmcnt(8)
    s_barrier
    s_add_u32 s52, s51, 7
    s_and_b32 s52, s52, 7
    s_mul_i32 s52, s52, 196608
    s_add_u32 s52, s52, s66
    s_xor_b32 s53, s52, 0
    s_add_u32 m0, s68, 147456
    s_add_u32 s53, s53, 1024
    buffer_load_dwordx4 v6, s[32:35], s53 offen lds
    buffer_load_dwordx4 v7, s[32:35], s53 offen offset:1024 lds
    s_xor_b32 s53, s52, 256
    s_add_u32 m0, s68, 155648
    s_add_u32 s53, s53, 2048
    buffer_load_dwordx4 v6, s[32:35], s53 offen lds
    buffer_load_dwordx4 v7, s[32:35], s53 offen offset:1024 lds
    s_waitcnt vmcnt(4)
    s_barrier
    s_add_u32 s52, s51, 7
    s_and_b32 s52, s52, 7
    s_lshl_b32 s52, s52, 7
    s_add_u32 m0, s67, 114688
    s_add_u32 s52, s52, s65
    buffer_load_dwordx4 v4, s[28:31], s52 offen lds
    buffer_load_dwordx4 v5, s[28:31], s52 offen offset:1024 lds
    s_add_u32 m0, s67, 116736
    s_add_u32 s52, s52, 16384
    buffer_load_dwordx4 v4, s[28:31], s52 offen lds
    buffer_load_dwordx4 v5, s[28:31], s52 offen offset:1024 lds
    buffer_load_dwordx4 v[172:175], v161, s[16:19], 0 offen
    s_waitcnt vmcnt(1)
    s_barrier
    s_add_u32 s52, s51, 0
    s_and_b32 s52, s52, 7
    s_mul_i32 s52, s52, 196608
    s_add_u32 s52, s52, s66
    s_xor_b32 s53, s52, 640
    s_add_u32 m0, s68, 131072
    s_add_u32 s53, s53, 0
    buffer_load_dwordx4 v6, s[36:39], s53 offen lds
    buffer_load_dwordx4 v7, s[36:39], s53 offen offset:1024 lds
    s_add_u32 s52, s51, 1
    s_and_b32 s52, s52, 7
    s_mul_i32 s52, s52, 196608
    s_add_u32 s52, s52, s66
    s_xor_b32 s53, s52, 640
    s_add_u32 m0, s68, 139264
    s_add_u32 s53, s53, 0
    buffer_load_dwordx4 v6, s[36:39], s53 offen lds
    buffer_load_dwordx4 v7, s[36:39], s53 offen offset:1024 lds
    s_barrier
    s_add_u32 s52, s51, 2
    s_and_b32 s52, s52, 7
    s_mul_i32 s52, s52, 196608
    s_add_u32 s52, s52, s66
    s_xor_b32 s53, s52, 640
    s_add_u32 m0, s68, 147456
    s_add_u32 s53, s53, 0
    buffer_load_dwordx4 v6, s[36:39], s53 offen lds
    buffer_load_dwordx4 v7, s[36:39], s53 offen offset:1024 lds
    s_add_u32 s52, s51, 3
    s_and_b32 s52, s52, 7
    s_mul_i32 s52, s52, 196608
    s_add_u32 s52, s52, s66
    s_xor_b32 s53, s52, 640
    s_add_u32 m0, s68, 155648
    s_add_u32 s53, s53, 0
    buffer_load_dwordx4 v6, s[36:39], s53 offen lds
    buffer_load_dwordx4 v7, s[36:39], s53 offen offset:1024 lds
    ds_read_b128 v[164:167], v160
    ds_read_b128 v[168:171], v160 offset:128
    s_waitcnt vmcnt(6) lgkmcnt(0)
    s_barrier
    v_dot2_f32_bf16 v156, v164, v172, v156
    v_dot2_f32_bf16 v157, v168, v172, v157
    v_dot2_f32_bf16 v156, v165, v173, v156
    v_dot2_f32_bf16 v157, v169, v173, v157
    v_dot2_f32_bf16 v156, v166, v174, v156
    v_dot2_f32_bf16 v157, v170, v174, v157
    v_dot2_f32_bf16 v156, v167, v175, v156
    v_dot2_f32_bf16 v157, v171, v175, v157
    s_nop 2
    v_permlane32_swap_b32 v156, v157
    s_nop 1
    v_add_f32 v156, v156, v157
    s_nop 1
    v_add_f32_dpp v156, v156, v156 quad_perm:[1,0,3,2] row_mask:0xf bank_mask:0xf
    s_nop 1
    v_add_f32_dpp v156, v156, v156 quad_perm:[2,3,0,1] row_mask:0xf bank_mask:0xf
    s_nop 1
    v_add_f32_dpp v156, v156, v156 row_half_mirror row_mask:0xf bank_mask:0xf
    s_nop 1
    v_add_f32_dpp v156, v156, v156 row_mirror row_mask:0xf bank_mask:0xf
    v_mov_b32 v157, v156
    s_nop 1
    v_permlane16_swap_b32 v156, v157
    s_nop 1
    v_add_f32 v156, v156, v157
    v_mul_f32 v156, 0xbfb8aa3b, v156
    v_exp_f32 v156, v156
    s_nop 0
    v_add_f32 v156, 1.0, v156
    v_rcp_f32 v156, v156
    s_waitcnt vmcnt(4)
    s_barrier
    s_add_u32 s52, s51, 4
    s_and_b32 s52, s52, 7
    s_mul_i32 s52, s52, 196608
    s_add_u32 s52, s52, s66
    s_xor_b32 s53, s52, 640
    s_add_u32 m0, s68, 131072
    s_add_u32 s53, s53, 0
    buffer_load_dwordx4 v6, s[36:39], s53 offen lds
    buffer_load_dwordx4 v7, s[36:39], s53 offen offset:1024 lds
    buffer_load_dwordx4 v[180:183], v162, s[12:15], s45 offen
    s_waitcnt vmcnt(5)
    s_barrier
    s_add_u32 s52, s51, 5
    s_and_b32 s52, s52, 7
    s_mul_i32 s52, s52, 196608
    s_add_u32 s52, s52, s66
    s_xor_b32 s53, s52, 640
    s_add_u32 m0, s68, 139264
    s_add_u32 s53, s53, 0
    buffer_load_dwordx4 v6, s[36:39], s53 offen lds
    buffer_load_dwordx4 v7, s[36:39], s53 offen offset:1024 lds
    s_waitcnt vmcnt(5)
    s_barrier
    s_add_u32 s52, s51, 6
    s_and_b32 s52, s52, 7
    s_mul_i32 s52, s52, 196608
    s_add_u32 s52, s52, s66
    s_xor_b32 s53, s52, 640
    s_add_u32 m0, s68, 147456
    s_add_u32 s53, s53, 0
    buffer_load_dwordx4 v6, s[36:39], s53 offen lds
    buffer_load_dwordx4 v7, s[36:39], s53 offen offset:1024 lds
    s_waitcnt vmcnt(5)
    s_barrier
    s_add_u32 s52, s51, 7
    s_and_b32 s52, s52, 7
    s_mul_i32 s52, s52, 196608
    s_add_u32 s52, s52, s66
    s_xor_b32 s53, s52, 640
    s_add_u32 m0, s68, 155648
    s_add_u32 s53, s53, 0
    buffer_load_dwordx4 v6, s[36:39], s53 offen lds
    buffer_load_dwordx4 v7, s[36:39], s53 offen offset:1024 lds
    v_mov_b32 v154, 55296
    ds_write_b32 v154, v3
    s_waitcnt vmcnt(4)
    s_barrier
    s_waitcnt vmcnt(2) lgkmcnt(0)
    s_barrier
    s_waitcnt vmcnt(0)
    s_branch L_ldj
L_ld1:
    s_waitcnt vmcnt(6)
    s_barrier
    s_add_u32 s52, s51, 2
    s_and_b32 s52, s52, 7
    s_mul_i32 s52, s52, 196608
    s_add_u32 s52, s52, s66
    s_xor_b32 s53, s52, 128
    s_add_u32 m0, s68, 147456
    s_add_u32 s53, s53, 0
    buffer_load_dwordx4 v6, s[32:35], s53 offen lds
    buffer_load_dwordx4 v7, s[32:35], s53 offen offset:1024 lds
    s_add_u32 s52, s51, 2
    s_and_b32 s52, s52, 7
    s_lshl_b32 s52, s52, 7
    s_add_u32 m0, s67, 32768
    s_add_u32 s52, s52, s65
    buffer_load_dwordx4 v4, s[28:31], s52 offen lds
    buffer_load_dwordx4 v5, s[28:31], s52 offen offset:1024 lds
    s_add_u32 m0, s67, 34816
    s_add_u32 s52, s52, 16384
    buffer_load_dwordx4 v4, s[28:31], s52 offen lds
    buffer_load_dwordx4 v5, s[28:31], s52 offen offset:1024 lds
    s_waitcnt vmcnt(6)
    s_barrier
    s_add_u32 s52, s51, 3
    s_and_b32 s52, s52, 7
    s_mul_i32 s52, s52, 196608
    s_add_u32 s52, s52, s66
    s_xor_b32 s53, s52, 128
    s_add_u32 m0, s68, 155648
    s_add_u32 s53, s53, 0
    buffer_load_dwordx4 v6, s[32:35], s53 offen lds
    buffer_load_dwordx4 v7, s[32:35], s53 offen offset:1024 lds
    s_add_u32 s52, s51, 3
    s_and_b32 s52, s52, 7
    s_lshl_b32 s52, s52, 7
    s_add_u32 m0, s67, 49152
    s_add_u32 s52, s52, s65
    buffer_load_dwordx4 v4, s[28:31], s52 offen lds
    buffer_load_dwordx4 v5, s[28:31], s52 offen offset:1024 lds
    s_add_u32 m0, s67, 51200
    s_add_u32 s52, s52, 16384
    buffer_load_dwordx4 v4, s[28:31], s52 offen lds
    buffer_load_dwordx4 v5, s[28:31], s52 offen offset:1024 lds
    s_waitcnt vmcnt(6)
    s_barrier
    s_add_u32 s52, s51, 4
    s_and_b32 s52, s52, 7
    s_mul_i32 s52, s52, 196608
    s_add_u32 s52, s52, s66
    s_xor_b32 s53, s52, 128
    s_add_u32 m0, s68, 131072
    s_add_u32 s53, s53, 0
    buffer_load_dwordx4 v6, s[32:35], s53 offen lds
    buffer_load_dwordx4 v7, s[32:35], s53 offen offset:1024 lds
    s_add_u32 s52, s51, 4
    s_and_b32 s52, s52, 7
    s_lshl_b32 s52, s52, 7
    s_add_u32 m0, s67, 65536
    s_add_u32 s52, s52, s65
    buffer_load_dwordx4 v4, s[28:31], s52 offen lds
    buffer_load_dwordx4 v5, s[28:31], s52 offen offset:1024 lds
    s_add_u32 m0, s67, 67584
    s_add_u32 s52, s52, 16384
    buffer_load_dwordx4 v4, s[28:31], s52 offen lds
    buffer_load_dwordx4 v5, s[28:31], s52 offen offset:1024 lds
    s_waitcnt vmcnt(6)
    s_barrier
    s_add_u32 s52, s51, 5
    s_and_b32 s52, s52, 7
    s_mul_i32 s52, s52, 196608
    s_add_u32 s52, s52, s66
    s_xor_b32 s53, s52, 128
    s_add_u32 m0, s68, 139264
    s_add_u32 s53, s53, 0
    buffer_load_dwordx4 v6, s[32:35], s53 offen lds
    buffer_load_dwordx4 v7, s[32:35], s53 offen offset:1024 lds
    s_add_u32 s52, s51, 5
    s_and_b32 s52, s52, 7
    s_lshl_b32 s52, s52, 7
    s_add_u32 m0, s67, 81920
    s_add_u32 s52, s52, s65
    buffer_load_dwordx4 v4, s[28:31], s52 offen lds
    buffer_load_dwordx4 v5, s[28:31], s52 offen offset:1024 lds
    s_add_u32 m0, s67, 83968
    s_add_u32 s52, s52, 16384
    buffer_load_dwordx4 v4, s[28:31], s52 offen lds
    buffer_load_dwordx4 v5, s[28:31], s52 offen offset:1024 lds
    s_waitcnt vmcnt(6)
    s_barrier
    s_add_u32 s52, s51, 6
    s_and_b32 s52, s52, 7
    s_mul_i32 s52, s52, 196608
    s_add_u32 s52, s52, s66
    s_xor_b32 s53, s52, 128
    s_add_u32 m0, s68, 147456
    s_add_u32 s53, s53, 0
    buffer_load_dwordx4 v6, s[32:35], s53 offen lds
    buffer_load_dwordx4 v7, s[32:35], s53 offen offset:1024 lds
    s_add_u32 s52, s51, 6
    s_and_b32 s52, s52, 7
    s_lshl_b32 s52, s52, 7
    s_add_u32 m0, s67, 98304
    s_add_u32 s52, s52, s65
    buffer_load_dwordx4 v4, s[28:31], s52 offen lds
    buffer_load_dwordx4 v5, s[28:31], s52 offen offset:1024 lds
    s_add_u32 m0, s67, 100352
    s_add_u32 s52, s52, 16384
    buffer_load_dwordx4 v4, s[28:31], s52 offen lds
    buffer_load_dwordx4 v5, s[28:31], s52 offen offset:1024 lds
    s_waitcnt vmcnt(6)
    s_barrier
    s_add_u32 s52, s51, 7
    s_and_b32 s52, s52, 7
    s_mul_i32 s52, s52, 196608
    s_add_u32 s52, s52, s66
    s_xor_b32 s53, s52, 128
    s_add_u32 m0, s68, 155648
    s_add_u32 s53, s53, 0
    buffer_load_dwordx4 v6, s[32:35], s53 offen lds
    buffer_load_dwordx4 v7, s[32:35], s53 offen offset:1024 lds
    s_add_u32 s52, s51, 7
    s_and_b32 s52, s52, 7
    s_lshl_b32 s52, s52, 7
    s_add_u32 m0, s67, 114688
    s_add_u32 s52, s52, s65
    buffer_load_dwordx4 v4, s[28:31], s52 offen lds
    buffer_load_dwordx4 v5, s[28:31], s52 offen offset:1024 lds
    s_add_u32 m0, s67, 116736
    s_add_u32 s52, s52, 16384
    buffer_load_dwordx4 v4, s[28:31], s52 offen lds
    buffer_load_dwordx4 v5, s[28:31], s52 offen offset:1024 lds
    s_waitcnt vmcnt(6)
    s_barrier
    s_add_u32 s52, s51, 0
    s_and_b32 s52, s52, 7
    s_mul_i32 s52, s52, 196608
    s_add_u32 s52, s52, s66
    s_xor_b32 s53, s52, 512
    s_add_u32 m0, s68, 131072
    s_add_u32 s53, s53, 1024
    buffer_load_dwordx4 v6, s[36:39], s53 offen lds
    buffer_load_dwordx4 v7, s[36:39], s53 offen offset:1024 lds
    s_xor_b32 s53, s52, 512
    s_add_u32 m0, s68, 139264
    s_add_u32 s53, s53, 2048
    buffer_load_dwordx4 v6, s[36:39], s53 offen lds
    buffer_load_dwordx4 v7, s[36:39], s53 offen offset:1024 lds
    buffer_load_dwordx4 v[172:175], v161, s[16:19], 0 offen
    s_waitcnt vmcnt(5)
    s_barrier
    s_barrier
    s_add_u32 s52, s51, 1
    s_and_b32 s52, s52, 7
    s_mul_i32 s52, s52, 196608
    s_add_u32 s52, s52, s66
    s_xor_b32 s53, s52, 512
    s_add_u32 m0, s68, 147456
    s_add_u32 s53, s53, 1024
    buffer_load_dwordx4 v6, s[36:39], s53 offen lds
    buffer_load_dwordx4 v7, s[36:39], s53 offen offset:1024 lds
    s_xor_b32 s53, s52, 512
    s_add_u32 m0, s68, 155648
    s_add_u32 s53, s53, 2048
    buffer_load_dwordx4 v6, s[36:39], s53 offen lds
    buffer_load_dwordx4 v7, s[36:39], s53 offen offset:1024 lds
    ds_read_b128 v[164:167], v160
    ds_read_b128 v[168:171], v160 offset:128
    s_waitcnt vmcnt(5) lgkmcnt(0)
    s_barrier
    s_waitcnt vmcnt(0)
    s_barrier
    s_add_u32 s52, s51, 2
    s_and_b32 s52, s52, 7
    s_mul_i32 s52, s52, 196608
    s_add_u32 s52, s52, s66
    s_xor_b32 s53, s52, 512
    s_add_u32 m0, s68, 131072
    s_add_u32 s53, s53, 1024
    buffer_load_dwordx4 v6, s[36:39], s53 offen lds
    buffer_load_dwordx4 v7, s[36:39], s53 offen offset:1024 lds
    s_xor_b32 s53, s52, 512
    s_add_u32 m0, s68, 139264
    s_add_u32 s53, s53, 2048
    buffer_load_dwordx4 v6, s[36:39], s53 offen lds
    buffer_load_dwordx4 v7, s[36:39], s53 offen offset:1024 lds
    s_add_u32 s52, s51, 3
    s_and_b32 s52, s52, 7
    s_mul_i32 s52, s52, 196608
    s_add_u32 s52, s52, s66
    s_xor_b32 s53, s52, 512
    s_add_u32 m0, s68, 0
    s_add_u32 s53, s53, 1024
    buffer_load_dwordx4 v6, s[36:39], s53 offen lds
    buffer_load_dwordx4 v7, s[36:39], s53 offen offset:1024 lds
    s_xor_b32 s53, s52, 512
    s_add_u32 m0, s68, 8192
    s_add_u32 s53, s53, 2048
    buffer_load_dwordx4 v6, s[36:39], s53 offen lds
    buffer_load_dwordx4 v7, s[36:39], s53 offen offset:1024 lds
    s_waitcnt vmcnt(4)
    s_barrier
    s_add_u32 s52, s51, 4
    s_and_b32 s52, s52, 7
    s_mul_i32 s52, s52, 196608
    s_add_u32 s52, s52, s66
    s_xor_b32 s53, s52, 512
    s_add_u32 m0, s68, 147456
    s_add_u32 s53, s53, 1024
    buffer_load_dwordx4 v6, s[36:39], s53 offen lds
    buffer_load_dwordx4 v7, s[36:39], s53 offen offset:1024 lds
    s_xor_b32 s53, s52, 512
    s_add_u32 m0, s68, 155648
    s_add_u32 s53, s53, 2048
    buffer_load_dwordx4 v6, s[36:39], s53 offen lds
    buffer_load_dwordx4 v7, s[36:39], s53 offen offset:1024 lds
    s_waitcnt vmcnt(4)
    s_barrier
    s_add_u32 s52, s51, 5
    s_and_b32 s52, s52, 7
    s_mul_i32 s52, s52, 196608
    s_add_u32 s52, s52, s66
    s_xor_b32 s53, s52, 512
    s_add_u32 m0, s68, 16384
    s_add_u32 s53, s53, 1024
    buffer_load_dwordx4 v6, s[36:39], s53 offen lds
    buffer_load_dwordx4 v7, s[36:39], s53 offen offset:1024 lds
    s_xor_b32 s53, s52, 512
    s_add_u32 m0, s68, 24576
    s_add_u32 s53, s53, 2048
    buffer_load_dwordx4 v6, s[36:39], s53 offen lds
    buffer_load_dwordx4 v7, s[36:39], s53 offen offset:1024 lds
    s_waitcnt vmcnt(4)
    s_barrier
    s_add_u32 s52, s51, 6
    s_and_b32 s52, s52, 7
    s_mul_i32 s52, s52, 196608
    s_add_u32 s52, s52, s66
    s_xor_b32 s53, s52, 512
    s_add_u32 m0, s68, 131072
    s_add_u32 s53, s53, 1024
    buffer_load_dwordx4 v6, s[36:39], s53 offen lds
    buffer_load_dwordx4 v7, s[36:39], s53 offen offset:1024 lds
    s_xor_b32 s53, s52, 512
    s_add_u32 m0, s68, 139264
    s_add_u32 s53, s53, 2048
    buffer_load_dwordx4 v6, s[36:39], s53 offen lds
    buffer_load_dwordx4 v7, s[36:39], s53 offen offset:1024 lds
    v_mov_b32 v154, 55296
    ds_write_b32 v154, v3
    v_dot2_f32_bf16 v156, v164, v172, v156
    v_dot2_f32_bf16 v157, v168, v172, v157
    v_dot2_f32_bf16 v156, v165, v173, v156
    v_dot2_f32_bf16 v157, v169, v173, v157
    v_dot2_f32_bf16 v156, v166, v174, v156
    v_dot2_f32_bf16 v157, v170, v174, v157
    v_dot2_f32_bf16 v156, v167, v175, v156
    v_dot2_f32_bf16 v157, v171, v175, v157
    s_nop 2
    v_permlane32_swap_b32 v156, v157
    s_nop 1
    v_add_f32 v156, v156, v157
    s_nop 1
    v_add_f32_dpp v156, v156, v156 quad_perm:[1,0,3,2] row_mask:0xf bank_mask:0xf
    s_nop 1
    v_add_f32_dpp v156, v156, v156 quad_perm:[2,3,0,1] row_mask:0xf bank_mask:0xf
    s_nop 1
    v_add_f32_dpp v156, v156, v156 row_half_mirror row_mask:0xf bank_mask:0xf
    s_nop 1
    v_add_f32_dpp v156, v156, v156 row_mirror row_mask:0xf bank_mask:0xf
    v_mov_b32 v157, v156
    s_nop 1
    v_permlane16_swap_b32 v156, v157
    s_nop 1
    v_add_f32 v156, v156, v157
    v_mul_f32 v156, 0xbfb8aa3b, v156
    v_exp_f32 v156, v156
    s_nop 0
    v_add_f32 v156, 1.0, v156
    v_rcp_f32 v156, v156
    s_waitcnt vmcnt(4)
    s_barrier
    s_add_u32 s52, s51, 7
    s_and_b32 s52, s52, 7
    s_mul_i32 s52, s52, 196608
    s_add_u32 s52, s52, s66
    s_xor_b32 s53, s52, 512
    s_add_u32 m0, s68, 147456
    s_add_u32 s53, s53, 1024
    buffer_load_dwordx4 v6, s[36:39], s53 offen lds
    buffer_load_dwordx4 v7, s[36:39], s53 offen offset:1024 lds
    s_xor_b32 s53, s52, 512
    s_add_u32 m0, s68, 155648
    s_add_u32 s53, s53, 2048
    buffer_load_dwordx4 v6, s[36:39], s53 offen lds
    buffer_load_dwordx4 v7, s[36:39], s53 offen offset:1024 lds
    s_waitcnt vmcnt(4) lgkmcnt(0)
    s_barrier
    buffer_load_dwordx4 v[180:183], v162, s[12:15], s45 offen
    s_waitcnt vmcnt(1)
L_ldj:
    s_setprio 3
    s_barrier
    v_add_u32 v162, s46, v1
    s_lshr_b32 s52, s26, 2
    s_lshl_b32 s52, s52, 8
    s_add_u32 s52, s52, 20056064
    v_min_u32 v41, 2, v0
    v_lshlrev_b32 v41, 11, v41
    s_sub_u32 s53, s8, 6291456
    s_lshr_b32 s53, s53, 1
    s_lshl_b32 s67, s26, 17
    s_add_u32 s67, s67, 2097152
    s_lshl_b32 s66, s64, 12
    s_add_u32 s55, s66, 65536
    s_cmp_eq_u32 s64, 0
    s_cmov_b32 s55, 16384
    s_mov_b32 s59, 0
    s_cmp_lg_u32 s64, 0
    s_cbranch_scc1 L_mbox
    buffer_load_dword v40, v41, s[40:43], s52 offen sc1
    s_waitcnt vmcnt(0)
    v_cmp_gt_u32 vcc, 16, v40
    s_nop 4
    s_cbranch_vccnz L_pollF1
L_pollF1_ok:
    ds_write_b32 v154, v44
L_mbox_ok:
    buffer_load_dwordx4 v[4:7], v1, s[40:43], s53 offen sc1
    buffer_load_dwordx4 v[8:11], v1, s[40:43], s53 offen offset:1024 sc1
    buffer_load_dwordx4 v[12:15], v1, s[40:43], s67 offen sc1
    s_add_u32 m0, s66, 0
    s_add_u32 s56, m0, s67
    buffer_load_dwordx4 v1, s[40:43], s56 offen offset:0 sc1 lds
    buffer_load_dwordx4 v1, s[40:43], s56 offen offset:1024 sc1 lds
    buffer_load_dwordx4 v1, s[40:43], s56 offen offset:2048 sc1 lds
    buffer_load_dwordx4 v1, s[40:43], s56 offen offset:3072 sc1 lds
    s_add_u32 m0, s55, 0
    s_add_u32 s56, m0, s67
    buffer_load_dwordx4 v1, s[40:43], s56 offen offset:0 sc1 lds
    buffer_load_dwordx4 v1, s[40:43], s56 offen offset:1024 sc1 lds
    buffer_load_dwordx4 v1, s[40:43], s56 offen offset:2048 sc1 lds
    buffer_load_dwordx4 v1, s[40:43], s56 offen offset:3072 sc1 lds
L_first_done:
    s_setprio 3
    s_waitcnt vmcnt(8)
    v_mfma_f32_32x32x16_bf16 v[80:95], v[12:15], v[4:7], 0
    v_mfma_f32_32x32x16_bf16 v[96:111], v[12:15], v[8:11], 0
    s_add_u32 m0, s66, 20480
    s_add_u32 s56, m0, s67
    buffer_load_dwordx4 v1, s[40:43], s56 offen offset:0 sc1 lds
    buffer_load_dwordx4 v1, s[40:43], s56 offen offset:1024 sc1 lds
    buffer_load_dwordx4 v1, s[40:43], s56 offen offset:2048 sc1 lds
    buffer_load_dwordx4 v1, s[40:43], s56 offen offset:3072 sc1 lds
    s_add_u32 m0, s66, 81920
    s_add_u32 s56, m0, s67
    buffer_load_dwordx4 v1, s[40:43], s56 offen offset:0 sc1 lds
    buffer_load_dwordx4 v1, s[40:43], s56 offen offset:1024 sc1 lds
    buffer_load_dwordx4 v1, s[40:43], s56 offen offset:2048 sc1 lds
    buffer_load_dwordx4 v1, s[40:43], s56 offen offset:3072 sc1 lds
    s_mov_b32 s65, 0
    s_mov_b32 s62, 0x0000ffff
    s_mov_b32 s63, 0x0000ffff
    v_max3_f32 v38, v80, v81, v82
    v_max3_f32 v39, v96, v97, v98
    v_max3_f32 v38, v38, v83, v84
    v_max3_f32 v39, v39, v99, v100
    v_max3_f32 v38, v38, v85, v86
    v_max3_f32 v39, v39, v101, v102
    v_max3_f32 v38, v38, v87, v88
    v_max3_f32 v39, v39, v103, v104
    v_max3_f32 v38, v38, v89, v90
    v_max3_f32 v39, v39, v105, v106
    v_max3_f32 v38, v38, v91, v92
    v_max3_f32 v39, v39, v107, v108
    v_max3_f32 v38, v38, v93, v94
    v_max3_f32 v39, v39, v109, v110
    v_max_f32 v38, v38, v95
    v_max_f32 v39, v39, v111
    s_nop 1
    v_permlane32_swap_b32 v38, v39
    s_nop 1
    v_max_f32 v38, v38, v39
    v_sub_f32 v38, 0, v38
    v_mov_b32 v39, v38
    s_nop 1
    v_permlane32_swap_b32 v38, v39
    s_nop 1
    v_mov_b64 v[158:159], v[38:39]
    v_mov_b32 v40, v38
    v_mov_b32 v41, v38
    v_mov_b64 v[48:49], v[40:41]
    v_mov_b64 v[50:51], v[40:41]
    v_mov_b64 v[52:53], v[40:41]
    v_mov_b64 v[54:55], v[40:41]
    v_mov_b64 v[56:57], v[40:41]
    v_mov_b64 v[58:59], v[40:41]
    v_mov_b64 v[60:61], v[40:41]
    v_mov_b64 v[62:63], v[40:41]
    v_mov_b32 v38, v39
    v_mov_b64 v[104:105], 0
    v_mov_b64 v[106:107], 0
    v_mov_b64 v[108:109], 0
    v_mov_b64 v[110:111], 0
    v_mfma_f32_32x32x16_bf16 v[80:95], v[12:15], v[4:7], v[48:63]
    v_mov_b64 v[64:65], v[38:39]
    v_mov_b64 v[66:67], v[38:39]
    v_mov_b64 v[68:69], v[38:39]
    v_mov_b64 v[70:71], v[38:39]
    v_mov_b64 v[72:73], v[38:39]
    v_mov_b64 v[74:75], v[38:39]
    v_mov_b64 v[76:77], v[38:39]
    v_mov_b64 v[78:79], v[38:39]
    ds_write_b64 v155, v[158:159]
    s_waitcnt vmcnt(0) lgkmcnt(0)
    s_barrier
    s_mov_b64 exec, s[62:63]
    ds_read_b128 v[20:23], v37 offset:1024
    ds_read_b128 v[24:27], v37 offset:1280
    s_mov_b64 exec, -1
    s_waitcnt lgkmcnt(0)
    s_branch L_slot0
L_compute:
    s_getpc_b64 s[52:53]
L_pc:
    s_sub_u32 s52, s52, L_pc-gated_mix__mha_block__linear_kernel_hedgehog__prompt_kernel
    s_subb_u32 s53, s53, 0
    s_lshr_b32 s54, s2, 3
    s_lshl_b32 s54, s54, 2
    s_add_u32 s54, s54, s48
    s_mul_i32 s54, s54, 320
    s_min_u32 s54, s54, L_codeend-gated_mix__mha_block__linear_kernel_hedgehog__prompt_kernel-320
    s_add_u32 s52, s52, s54
    s_addc_u32 s53, s53, 0
    s_load_dword s55, s[52:53], 0
    s_load_dword s56, s[52:53], 64
    s_load_dword s57, s[52:53], 128
    s_load_dword s58, s[52:53], 192
    s_load_dword s59, s[52:53], 256
    s_lshr_b32 s67, s48, 1
    s_and_b32 s68, s48, 1
    v_and_b32 v16, 31, v0
    v_lshrrev_b32 v17, 5, v0
    v_lshlrev_b32 v1, 4, v0
    s_waitcnt lgkmcnt(0)
    s_mov_b32 s44, s14
    s_mov_b32 s45, s15
    s_mov_b32 s46, 0x4000
    s_mov_b32 s47, 0x20000
    s_mov_b32 s40, s24
    s_mov_b32 s41, s25
    s_mov_b32 s42, 0x1322000
    s_mov_b32 s43, 0x20000
    s_or_b32 s53, s2, s48
    s_cmp_lg_u32 s53, 0
    s_cbranch_scc1 L_noinit
    v_lshlrev_b32 v8, 8, v0
    s_mov_b32 s53, 20054016
    buffer_store_dword v3, v8, s[40:43], s53 offen sc1
    s_waitcnt vmcnt(0)
    v_mov_b32 v8, 1
    s_mov_b64 exec, 1
    global_store_dword v3, v8, s[22:23] sc1
    s_mov_b64 exec, -1
L_noinit:
    s_lshr_b32 s54, s2, 3
    s_lshl_b32 s54, s54, 2
    s_add_u32 s54, s54, s48
    s_lshl_b32 s54, s54, 7
    s_add_u32 s55, s54, 64
    s_load_dword s38, s[14:15], s54
    s_load_dword s39, s[14:15], s55
    s_lshr_b32 s55, s54, 1
    s_and_b32 s55, s55, 0x3c0
    s_load_dword s33, s[18:19], s55
    s_lshl_b32 s55, s54, 5
    s_load_dword s34, s[8:9], s55
    s_load_dword s35, s[16:17], s55
    s_lshl_b32 s52, s49, 1
    s_add_u32 s52, s52, s68
    s_lshl_b32 s52, s52, 10
    s_bitcmp1_b32 s2, 5
    s_mov_b32 s53, 10240
    s_cmov_b32 s53, 8192
    s_xor_b32 s36, s52, s53
    s_lshl_b32 s32, s48, 10
    s_add_u32 s32, s32, 32768
    v_bfe_u32 v18, v0, 2, 2
    v_lshlrev_b32 v12, 5, v18
    v_lshl_add_u32 v12, v17, 8, v12
    v_bfe_u32 v18, v0, 4, 1
    v_lshl_add_u32 v12, v18, 4, v12
    v_bfe_u32 v18, v0, 1, 1
    v_lshl_add_u32 v12, v18, 3, v12
    v_add_u32 v12, s32, v12
    s_lshl_b32 s52, s67, 13
    v_and_b32 v20, 15, v0
    v_lshrrev_b32 v21, 4, v0
    v_lshlrev_b32 v19, 7, v20
    v_add_u32 v19, s52, v19
    v_lshrrev_b32 v18, 1, v20
    v_xor_b32 v18, v18, v21
    v_lshl_add_u32 v4, v18, 4, v19
    v_xor_b32 v5, 64, v4
    v_lshlrev_b32 v9, 10, v21
    v_bfe_u32 v18, v0, 2, 2
    v_lshl_add_u32 v9, v18, 7, v9
    v_bfe_u32 v18, v0, 3, 1
    v_xor_b32 v18, s68, v18
    v_lshl_add_u32 v9, v18, 6, v9
    v_bfe_u32 v18, v0, 4, 1
    v_lshl_add_u32 v9, v18, 5, v9
    v_and_b32 v19, 3, v0
    v_lshl_add_u32 v9, v19, 3, v9
    v_xor_b32 v7, 32, v9
    v_add_u32 v8, 98304, v9
    v_add_u32 v6, 98304, v7
    s_mov_b32 s60, 0x3fb8aa3b
    s_mov_b32 s61, 0x3eb8aa3b
    s_mov_b32 s62, 0x0000ffff
    s_mov_b32 s63, 0x0000ffff
    s_mov_b32 s65, 0
    s_lshl_b32 s69, s49, 1
    s_add_u32 s69, s69, s68
    s_lshl_b32 s69, s69, 7
    s_lshl_b32 s53, s50, 2
    s_add_u32 s69, s69, s53
    s_lshl_b32 s53, s67, 1
    s_add_u32 s69, s69, s53
    s_lshl_b32 s53, s48, 12
    s_add_u32 s53, s53, 131072
    v_lshlrev_b32 v240, 1, v17
    v_bfe_u32 v18, v16, 1, 2
    v_xor_b32 v240, v240, v18
    v_lshlrev_b32 v240, 4, v240
    v_lshl_add_u32 v240, v16, 6, v240
    v_add_u32 v240, s53, v240
    v_xor_b32 v241, 16, v240
    v_bfe_u32 v18, v0, 2, 2
    v_lshlrev_b32 v242, 6, v18
    v_lshrrev_b32 v18, 5, v0
    v_lshl_add_u32 v242, v18, 8, v242
    v_and_b32 v18, 1, v0
    v_lshl_add_u32 v242, v18, 5, v242
    v_bfe_u32 v18, v0, 4, 1
    v_lshl_add_u32 v242, v18, 4, v242
    v_bfe_u32 v18, v0, 1, 1
    v_lshl_add_u32 v242, v18, 3, v242
    v_add_u32 v242, s53, v242
    v_lshl_add_u32 v242, v17, 8, v242
    v_bfe_u32 v18, v0, 3, 1
    v_lshlrev_b32 v18, 4, v18
    v_xor_b32 v242, v242, v18
    v_xor_b32 v246, 32, v242
    v_mov_b32 v244, 0x3f803f80
    v_mov_b32 v245, 0x3f803f80
    v_and_b32 v18, 3, v0
    v_xor_b32 v14, s49, v18
    v_lshl_add_u32 v14, v0, 3, v14
    v_lshlrev_b32 v14, 8, v14
    v_mov_b32 v15, 1
    v_bfe_u32 v18, v0, 2, 1
    s_mov_b32 s53, 0x80008000
    v_mul_lo_u32 v13, v18, s53
    s_lshl_b32 s52, s48, 9
    s_add_u32 s52, s52, 53248
    v_lshrrev_b32 v243, 1, v1
    v_add_u32 v243, s52, v243
    s_mov_b32 s3, 1
    s_and_b32 s52, s48, 3
    s_lshl_b32 s53, s27, 3
    s_lshl_b32 s54, s52, 1
    s_add_u32 s53, s53, s54
    s_add_u32 s53, s53, 1
    s_lshl_b32 s4, s53, 5
    s_add_u32 s4, s4, s26
    s_lshl_b32 s4, s4, 10
    s_add_u32 s4, s4, 14680064
    s_lshl_b32 s8, s26, 6
    s_add_u32 s8, s8, s53
    s_lshl_b32 s8, s8, 11
    s_add_u32 s8, s8, 6291456
    s_lshr_b32 s5, s26, 2
    s_xor_b32 s5, s5, 4
    s_lshl_b32 s5, s5, 8
    s_add_u32 s5, s5, 20054016
    s_lshl_b32 s6, s26, 17
    s_lshl_b32 s54, s52, 10
    s_add_u32 s6, s6, s54
    s_lshl_b32 s54, s27, 7
    s_add_u32 s6, s6, s54
    s_add_u32 s6, s6, 10485760
    s_lshl_b32 s7, s26, 11
    s_add_u32 s7, s7, 18939904
    s_lshr_b32 s9, s2, 5
    s_lshl_b32 s9, s9, 17
    s_add_u32 s9, s9, 19005440
    s_lshr_b32 s53, s48, 1
    s_lshl_b32 s10, s53, 14
    s_add_u32 s10, s10, s9
    s_add_u32 s10, s10, 65536
    s_lshl_b32 s54, s48, 13
    s_add_u32 s9, s9, s54
    s_and_b32 s11, s2, 31
    s_lshl_b32 s11, s11, 1
    s_and_b32 s54, s48, 1
    s_add_u32 s11, s11, s54
    s_lshl_b32 s0, s11, 7
    s_add_u32 s0, s0, 18874368
    s_lshl_b32 s11, s11, 5
    s_lshl_b32 s53, s53, 3
    s_add_u32 s11, s11, s53
    s_lshl_b32 s11, s11, 10
    s_add_u32 s11, s11, 14680064
    s_lshl_b32 s1, s52, 13
    s_add_u32 s1, s1, 0
    s_bitcmp1_b32 s2, 5
    s_cbranch_scc1 L_cmp1
.p2align 3
L_cmp0:
    s_barrier
    s_nop 0
    ds_read_b128 v[112:115], v4 offset:0
    ds_read_b64_tr_b16 v[128:129], v8 offset:32768
    ds_read_b64_tr_b16 v[130:131], v8 offset:33280
    ds_read_b128 v[116:119], v4 offset:2048
    ds_read_b64_tr_b16 v[132:133], v6 offset:32768
    ds_read_b64_tr_b16 v[134:135], v6 offset:33280
    ds_read_b128 v[120:123], v4 offset:4096
    ds_read_b64_tr_b16 v[136:137], v8 offset:40960
    ds_read_b64_tr_b16 v[138:139], v8 offset:41472
    ds_read_b128 v[124:127], v4 offset:6144
    ds_read_b64_tr_b16 v[140:141], v6 offset:40960
    ds_read_b64_tr_b16 v[142:143], v6 offset:41472
    ds_read_b128 v[144:147], v5 offset:0
    ds_read_b64_tr_b16 v[160:161], v8 offset:36864
    ds_read_b64_tr_b16 v[162:163], v8 offset:37376
    ds_read_b128 v[148:151], v5 offset:2048
    ds_read_b64_tr_b16 v[164:165], v6 offset:36864
    ds_read_b64_tr_b16 v[166:167], v6 offset:37376
    ds_read_b128 v[152:155], v5 offset:4096
    ds_read_b64_tr_b16 v[168:169], v8 offset:45056
    ds_read_b64_tr_b16 v[170:171], v8 offset:45568
    ds_read_b128 v[156:159], v5 offset:6144
    ds_read_b64_tr_b16 v[172:173], v6 offset:45056
    ds_read_b64_tr_b16 v[174:175], v6 offset:45568
    s_waitcnt lgkmcnt(0)
    s_barrier
    v_mfma_f32_16x16x32_bf16 v[48:51], v[128:131], v[112:115], 0
    ds_read_b128 v[176:179], v4 offset:16384
    v_mfma_f32_16x16x32_bf16 v[52:55], v[128:131], v[116:119], 0
    ds_read_b64_tr_b16 v[192:193], v8 offset:49152
    v_mfma_f32_16x16x32_bf16 v[64:67], v[128:131], v[120:123], 0
    ds_read_b64_tr_b16 v[194:195], v8 offset:49664
    v_mfma_f32_16x16x32_bf16 v[68:71], v[128:131], v[124:127], 0
    ds_read_b128 v[180:183], v4 offset:18432
    v_mfma_f32_16x16x32_bf16 v[56:59], v[132:135], v[112:115], 0
    ds_read_b64_tr_b16 v[196:197], v6 offset:49152
    v_mfma_f32_16x16x32_bf16 v[60:63], v[132:135], v[116:119], 0
    ds_read_b64_tr_b16 v[198:199], v6 offset:49664
    v_mfma_f32_16x16x32_bf16 v[72:75], v[132:135], v[120:123], 0
    ds_read_b128 v[184:187], v4 offset:20480
    v_mfma_f32_16x16x32_bf16 v[76:79], v[132:135], v[124:127], 0
    ds_read_b64_tr_b16 v[200:201], v8 offset:57344
    v_mfma_f32_16x16x32_bf16 v[80:83], v[112:115], v[136:139], 0
    ds_read_b64_tr_b16 v[202:203], v8 offset:57856
    v_mfma_f32_16x16x32_bf16 v[84:87], v[116:119], v[136:139], 0
    ds_read_b128 v[188:191], v4 offset:22528
    v_mfma_f32_16x16x32_bf16 v[96:99], v[120:123], v[136:139], 0
    ds_read_b64_tr_b16 v[204:205], v6 offset:57344
    v_mfma_f32_16x16x32_bf16 v[100:103], v[124:127], v[136:139], 0
    ds_read_b64_tr_b16 v[206:207], v6 offset:57856
    v_mfma_f32_16x16x32_bf16 v[88:91], v[112:115], v[140:143], 0
    ds_read_b128 v[208:211], v5 offset:16384
    v_mfma_f32_16x16x32_bf16 v[92:95], v[116:119], v[140:143], 0
    ds_read_b64_tr_b16 v[224:225], v8 offset:53248
    v_mfma_f32_16x16x32_bf16 v[104:107], v[120:123], v[140:143], 0
    ds_read_b64_tr_b16 v[226:227], v8 offset:53760
    v_mfma_f32_16x16x32_bf16 v[108:111], v[124:127], v[140:143], 0
    ds_read_b128 v[212:215], v5 offset:18432
    v_mfma_f32_16x16x32_bf16 v[48:51], v[160:163], v[144:147], v[48:51]
    ds_read_b64_tr_b16 v[228:229], v6 offset:53248
    v_mfma_f32_16x16x32_bf16 v[52:55], v[160:163], v[148:151], v[52:55]
    ds_read_b64_tr_b16 v[230:231], v6 offset:53760
    v_mfma_f32_16x16x32_bf16 v[64:67], v[160:163], v[152:155], v[64:67]
    ds_read_b128 v[216:219], v5 offset:20480
    v_mfma_f32_16x16x32_bf16 v[68:71], v[160:163], v[156:159], v[68:71]
    ds_read_b64_tr_b16 v[232:233], v8 offset:61440
    v_mfma_f32_16x16x32_bf16 v[56:59], v[164:167], v[144:147], v[56:59]
    ds_read_b64_tr_b16 v[234:235], v8 offset:61952
    v_mfma_f32_16x16x32_bf16 v[60:63], v[164:167], v[148:151], v[60:63]
    ds_read_b128 v[220:223], v5 offset:22528
    v_mfma_f32_16x16x32_bf16 v[72:75], v[164:167], v[152:155], v[72:75]
    ds_read_b64_tr_b16 v[236:237], v6 offset:61440
    v_mfma_f32_16x16x32_bf16 v[76:79], v[164:167], v[156:159], v[76:79]
    ds_read_b64_tr_b16 v[238:239], v6 offset:61952
    v_mfma_f32_16x16x32_bf16 v[80:83], v[144:147], v[168:171], v[80:83]
    v_mfma_f32_16x16x32_bf16 v[84:87], v[148:151], v[168:171], v[84:87]
    v_mfma_f32_16x16x32_bf16 v[96:99], v[152:155], v[168:171], v[96:99]
    v_mfma_f32_16x16x32_bf16 v[100:103], v[156:159], v[168:171], v[100:103]
    v_mfma_f32_16x16x32_bf16 v[88:91], v[144:147], v[172:175], v[88:91]
    v_mfma_f32_16x16x32_bf16 v[92:95], v[148:151], v[172:175], v[92:95]
    v_mfma_f32_16x16x32_bf16 v[104:107], v[152:155], v[172:175], v[104:107]
    v_mfma_f32_16x16x32_bf16 v[108:111], v[156:159], v[172:175], v[108:111]
    s_waitcnt lgkmcnt(0)
    s_barrier
    v_mfma_f32_16x16x32_bf16 v[48:51], v[192:195], v[176:179], v[48:51]
    ds_read_b128 v[112:115], v4 offset:32768
    v_mfma_f32_16x16x32_bf16 v[52:55], v[192:195], v[180:183], v[52:55]
    ds_read_b64_tr_b16 v[128:129], v8 offset:16384
    v_mfma_f32_16x16x32_bf16 v[64:67], v[192:195], v[184:187], v[64:67]
    ds_read_b64_tr_b16 v[130:131], v8 offset:16896
    v_mfma_f32_16x16x32_bf16 v[68:71], v[192:195], v[188:191], v[68:71]
    ds_read_b128 v[116:119], v4 offset:34816
    v_mfma_f32_16x16x32_bf16 v[56:59], v[196:199], v[176:179], v[56:59]
    ds_read_b64_tr_b16 v[132:133], v6 offset:16384
    v_mfma_f32_16x16x32_bf16 v[60:63], v[196:199], v[180:183], v[60:63]
    ds_read_b64_tr_b16 v[134:135], v6 offset:16896
    v_mfma_f32_16x16x32_bf16 v[72:75], v[196:199], v[184:187], v[72:75]
    ds_read_b128 v[120:123], v4 offset:36864
    v_mfma_f32_16x16x32_bf16 v[76:79], v[196:199], v[188:191], v[76:79]
    ds_read_b64_tr_b16 v[136:137], v8 offset:24576
    v_mfma_f32_16x16x32_bf16 v[80:83], v[176:179], v[200:203], v[80:83]
    ds_read_b64_tr_b16 v[138:139], v8 offset:25088
    v_mfma_f32_16x16x32_bf16 v[84:87], v[180:183], v[200:203], v[84:87]
    ds_read_b128 v[124:127], v4 offset:38912
    v_mfma_f32_16x16x32_bf16 v[96:99], v[184:187], v[200:203], v[96:99]
    ds_read_b64_tr_b16 v[140:141], v6 offset:24576
    v_mfma_f32_16x16x32_bf16 v[100:103], v[188:191], v[200:203], v[100:103]
    ds_read_b64_tr_b16 v[142:143], v6 offset:25088
    v_mfma_f32_16x16x32_bf16 v[88:91], v[176:179], v[204:207], v[88:91]
    ds_read_b128 v[144:147], v5 offset:32768
    v_mfma_f32_16x16x32_bf16 v[92:95], v[180:183], v[204:207], v[92:95]
    ds_read_b64_tr_b16 v[160:161], v8 offset:20480
    v_mfma_f32_16x16x32_bf16 v[104:107], v[184:187], v[204:207], v[104:107]
    ds_read_b64_tr_b16 v[162:163], v8 offset:20992
    v_mfma_f32_16x16x32_bf16 v[108:111], v[188:191], v[204:207], v[108:111]
    ds_read_b128 v[148:151], v5 offset:34816
    v_mfma_f32_16x16x32_bf16 v[48:51], v[224:227], v[208:211], v[48:51]
    ds_read_b64_tr_b16 v[164:165], v6 offset:20480
    v_mfma_f32_16x16x32_bf16 v[52:55], v[224:227], v[212:215], v[52:55]
    ds_read_b64_tr_b16 v[166:167], v6 offset:20992
    v_mfma_f32_16x16x32_bf16 v[64:67], v[224:227], v[216:219], v[64:67]
    ds_read_b128 v[152:155], v5 offset:36864
    v_mfma_f32_16x16x32_bf16 v[68:71], v[224:227], v[220:223], v[68:71]
    ds_read_b64_tr_b16 v[168:169], v8 offset:28672
    v_mfma_f32_16x16x32_bf16 v[56:59], v[228:231], v[208:211], v[56:59]
    ds_read_b64_tr_b16 v[170:171], v8 offset:29184
    v_mfma_f32_16x16x32_bf16 v[60:63], v[228:231], v[212:215], v[60:63]
    ds_read_b128 v[156:159], v5 offset:38912
    v_mfma_f32_16x16x32_bf16 v[72:75], v[228:231], v[216:219], v[72:75]
    ds_read_b64_tr_b16 v[172:173], v6 offset:28672
    v_mfma_f32_16x16x32_bf16 v[76:79], v[228:231], v[220:223], v[76:79]
    ds_read_b64_tr_b16 v[174:175], v6 offset:29184
    v_mfma_f32_16x16x32_bf16 v[80:83], v[208:211], v[232:235], v[80:83]
    v_mfma_f32_16x16x32_bf16 v[84:87], v[212:215], v[232:235], v[84:87]
    v_mfma_f32_16x16x32_bf16 v[96:99], v[216:219], v[232:235], v[96:99]
    v_mfma_f32_16x16x32_bf16 v[100:103], v[220:223], v[232:235], v[100:103]
    v_mfma_f32_16x16x32_bf16 v[88:91], v[208:211], v[236:239], v[88:91]
    v_mfma_f32_16x16x32_bf16 v[92:95], v[212:215], v[236:239], v[92:95]
    v_mfma_f32_16x16x32_bf16 v[104:107], v[216:219], v[236:239], v[104:107]
    v_mfma_f32_16x16x32_bf16 v[108:111], v[220:223], v[236:239], v[108:111]
    s_waitcnt lgkmcnt(0)
    s_barrier
    v_mfma_f32_16x16x32_bf16 v[48:51], v[128:131], v[112:115], v[48:51]
    ds_read_b128 v[176:179], v4 offset:49152
    v_mfma_f32_16x16x32_bf16 v[52:55], v[128:131], v[116:119], v[52:55]
    ds_read_b64_tr_b16 v[192:193], v8 offset:32768
    v_mfma_f32_16x16x32_bf16 v[64:67], v[128:131], v[120:123], v[64:67]
    ds_read_b64_tr_b16 v[194:195], v8 offset:33280
    v_mfma_f32_16x16x32_bf16 v[68:71], v[128:131], v[124:127], v[68:71]
    ds_read_b128 v[180:183], v4 offset:51200
    v_mfma_f32_16x16x32_bf16 v[56:59], v[132:135], v[112:115], v[56:59]
    ds_read_b64_tr_b16 v[196:197], v6 offset:32768
    v_mfma_f32_16x16x32_bf16 v[60:63], v[132:135], v[116:119], v[60:63]
    ds_read_b64_tr_b16 v[198:199], v6 offset:33280
    v_mfma_f32_16x16x32_bf16 v[72:75], v[132:135], v[120:123], v[72:75]
    ds_read_b128 v[184:187], v4 offset:53248
    v_mfma_f32_16x16x32_bf16 v[76:79], v[132:135], v[124:127], v[76:79]
    ds_read_b64_tr_b16 v[200:201], v8 offset:40960
    v_mfma_f32_16x16x32_bf16 v[80:83], v[112:115], v[136:139], v[80:83]
    ds_read_b64_tr_b16 v[202:203], v8 offset:41472
    v_mfma_f32_16x16x32_bf16 v[84:87], v[116:119], v[136:139], v[84:87]
    ds_read_b128 v[188:191], v4 offset:55296
    v_mfma_f32_16x16x32_bf16 v[96:99], v[120:123], v[136:139], v[96:99]
    ds_read_b64_tr_b16 v[204:205], v6 offset:40960
    v_mfma_f32_16x16x32_bf16 v[100:103], v[124:127], v[136:139], v[100:103]
    ds_read_b64_tr_b16 v[206:207], v6 offset:41472
    v_mfma_f32_16x16x32_bf16 v[88:91], v[112:115], v[140:143], v[88:91]
    ds_read_b128 v[208:211], v5 offset:49152
    v_mfma_f32_16x16x32_bf16 v[92:95], v[116:119], v[140:143], v[92:95]
    ds_read_b64_tr_b16 v[224:225], v8 offset:36864
    v_mfma_f32_16x16x32_bf16 v[104:107], v[120:123], v[140:143], v[104:107]
    ds_read_b64_tr_b16 v[226:227], v8 offset:37376
    v_mfma_f32_16x16x32_bf16 v[108:111], v[124:127], v[140:143], v[108:111]
    ds_read_b128 v[212:215], v5 offset:51200
    v_mfma_f32_16x16x32_bf16 v[48:51], v[160:163], v[144:147], v[48:51]
    ds_read_b64_tr_b16 v[228:229], v6 offset:36864
    v_mfma_f32_16x16x32_bf16 v[52:55], v[160:163], v[148:151], v[52:55]
    ds_read_b64_tr_b16 v[230:231], v6 offset:37376
    v_mfma_f32_16x16x32_bf16 v[64:67], v[160:163], v[152:155], v[64:67]
    ds_read_b128 v[216:219], v5 offset:53248
    v_mfma_f32_16x16x32_bf16 v[68:71], v[160:163], v[156:159], v[68:71]
    ds_read_b64_tr_b16 v[232:233], v8 offset:45056
    v_mfma_f32_16x16x32_bf16 v[56:59], v[164:167], v[144:147], v[56:59]
    ds_read_b64_tr_b16 v[234:235], v8 offset:45568
    v_mfma_f32_16x16x32_bf16 v[60:63], v[164:167], v[148:151], v[60:63]
    ds_read_b128 v[220:223], v5 offset:55296
    v_mfma_f32_16x16x32_bf16 v[72:75], v[164:167], v[152:155], v[72:75]
    ds_read_b64_tr_b16 v[236:237], v6 offset:45056
    v_mfma_f32_16x16x32_bf16 v[76:79], v[164:167], v[156:159], v[76:79]
    ds_read_b64_tr_b16 v[238:239], v6 offset:45568
    v_mfma_f32_16x16x32_bf16 v[80:83], v[144:147], v[168:171], v[80:83]
    v_mfma_f32_16x16x32_bf16 v[84:87], v[148:151], v[168:171], v[84:87]
    v_mfma_f32_16x16x32_bf16 v[96:99], v[152:155], v[168:171], v[96:99]
    v_mfma_f32_16x16x32_bf16 v[100:103], v[156:159], v[168:171], v[100:103]
    v_mfma_f32_16x16x32_bf16 v[88:91], v[144:147], v[172:175], v[88:91]
    v_mfma_f32_16x16x32_bf16 v[92:95], v[148:151], v[172:175], v[92:95]
    v_mfma_f32_16x16x32_bf16 v[104:107], v[152:155], v[172:175], v[104:107]
    v_mfma_f32_16x16x32_bf16 v[108:111], v[156:159], v[172:175], v[108:111]
    s_waitcnt lgkmcnt(0)
    s_barrier
    v_mfma_f32_16x16x32_bf16 v[48:51], v[192:195], v[176:179], v[48:51]
    v_xor_b32 v4, 0x10000, v4
    v_xor_b32 v5, 0x10000, v5
    v_mfma_f32_16x16x32_bf16 v[52:55], v[192:195], v[180:183], v[52:55]
    ds_read_b128 v[112:115], v4 offset:0
    v_mfma_f32_16x16x32_bf16 v[64:67], v[192:195], v[184:187], v[64:67]
    ds_read_b64_tr_b16 v[128:129], v8 offset:49152
    v_mfma_f32_16x16x32_bf16 v[68:71], v[192:195], v[188:191], v[68:71]
    ds_read_b64_tr_b16 v[130:131], v8 offset:49664
    v_mfma_f32_16x16x32_bf16 v[56:59], v[196:199], v[176:179], v[56:59]
    ds_read_b128 v[116:119], v4 offset:2048
    v_mfma_f32_16x16x32_bf16 v[60:63], v[196:199], v[180:183], v[60:63]
    ds_read_b64_tr_b16 v[132:133], v6 offset:49152
    v_mfma_f32_16x16x32_bf16 v[72:75], v[196:199], v[184:187], v[72:75]
    ds_read_b64_tr_b16 v[134:135], v6 offset:49664
    v_mfma_f32_16x16x32_bf16 v[76:79], v[196:199], v[188:191], v[76:79]
    ds_read_b128 v[120:123], v4 offset:4096
    v_mfma_f32_16x16x32_bf16 v[80:83], v[176:179], v[200:203], v[80:83]
    ds_read_b64_tr_b16 v[136:137], v8 offset:57344
    v_mfma_f32_16x16x32_bf16 v[84:87], v[180:183], v[200:203], v[84:87]
    ds_read_b64_tr_b16 v[138:139], v8 offset:57856
    v_mfma_f32_16x16x32_bf16 v[96:99], v[184:187], v[200:203], v[96:99]
    ds_read_b128 v[124:127], v4 offset:6144
    v_mfma_f32_16x16x32_bf16 v[100:103], v[188:191], v[200:203], v[100:103]
    ds_read_b64_tr_b16 v[140:141], v6 offset:57344
    v_mfma_f32_16x16x32_bf16 v[88:91], v[176:179], v[204:207], v[88:91]
    ds_read_b64_tr_b16 v[142:143], v6 offset:57856
    v_mfma_f32_16x16x32_bf16 v[92:95], v[180:183], v[204:207], v[92:95]
    ds_read_b128 v[144:147], v5 offset:0
    v_mfma_f32_16x16x32_bf16 v[104:107], v[184:187], v[204:207], v[104:107]
    ds_read_b64_tr_b16 v[160:161], v8 offset:53248
    v_mfma_f32_16x16x32_bf16 v[108:111], v[188:191], v[204:207], v[108:111]
    ds_read_b64_tr_b16 v[162:163], v8 offset:53760
    v_mfma_f32_16x16x32_bf16 v[48:51], v[224:227], v[208:211], v[48:51]
    ds_read_b128 v[148:151], v5 offset:2048
    v_mfma_f32_16x16x32_bf16 v[52:55], v[224:227], v[212:215], v[52:55]
    ds_read_b64_tr_b16 v[164:165], v6 offset:53248
    v_mfma_f32_16x16x32_bf16 v[64:67], v[224:227], v[216:219], v[64:67]
    ds_read_b64_tr_b16 v[166:167], v6 offset:53760
    v_mfma_f32_16x16x32_bf16 v[68:71], v[224:227], v[220:223], v[68:71]
    ds_read_b128 v[152:155], v5 offset:4096
    v_mfma_f32_16x16x32_bf16 v[56:59], v[228:231], v[208:211], v[56:59]
    ds_read_b64_tr_b16 v[168:169], v8 offset:61440
    v_mfma_f32_16x16x32_bf16 v[60:63], v[228:231], v[212:215], v[60:63]
    ds_read_b64_tr_b16 v[170:171], v8 offset:61952
    v_mfma_f32_16x16x32_bf16 v[72:75], v[228:231], v[216:219], v[72:75]
    ds_read_b128 v[156:159], v5 offset:6144
    v_mfma_f32_16x16x32_bf16 v[76:79], v[228:231], v[220:223], v[76:79]
    ds_read_b64_tr_b16 v[172:173], v6 offset:61440
    v_mfma_f32_16x16x32_bf16 v[80:83], v[208:211], v[232:235], v[80:83]
    ds_read_b64_tr_b16 v[174:175], v6 offset:61952
    v_mfma_f32_16x16x32_bf16 v[84:87], v[212:215], v[232:235], v[84:87]
    v_mfma_f32_16x16x32_bf16 v[96:99], v[216:219], v[232:235], v[96:99]
    v_mfma_f32_16x16x32_bf16 v[100:103], v[220:223], v[232:235], v[100:103]
    v_mfma_f32_16x16x32_bf16 v[88:91], v[208:211], v[236:239], v[88:91]
    v_mfma_f32_16x16x32_bf16 v[92:95], v[212:215], v[236:239], v[92:95]
    v_mfma_f32_16x16x32_bf16 v[104:107], v[216:219], v[236:239], v[104:107]
    v_mfma_f32_16x16x32_bf16 v[108:111], v[220:223], v[236:239], v[108:111]
    s_waitcnt lgkmcnt(0)
    s_barrier
    v_mfma_f32_16x16x32_bf16 v[48:51], v[128:131], v[112:115], v[48:51]
    ds_read_b128 v[176:179], v4 offset:16384
    v_mfma_f32_16x16x32_bf16 v[52:55], v[128:131], v[116:119], v[52:55]
    ds_read_b64_tr_b16 v[192:193], v8 offset:16384
    v_mfma_f32_16x16x32_bf16 v[64:67], v[128:131], v[120:123], v[64:67]
    ds_read_b64_tr_b16 v[194:195], v8 offset:16896
    v_mfma_f32_16x16x32_bf16 v[68:71], v[128:131], v[124:127], v[68:71]
    ds_read_b128 v[180:183], v4 offset:18432
    v_mfma_f32_16x16x32_bf16 v[56:59], v[132:135], v[112:115], v[56:59]
    ds_read_b64_tr_b16 v[196:197], v6 offset:16384
    v_mfma_f32_16x16x32_bf16 v[60:63], v[132:135], v[116:119], v[60:63]
    ds_read_b64_tr_b16 v[198:199], v6 offset:16896
    v_mfma_f32_16x16x32_bf16 v[72:75], v[132:135], v[120:123], v[72:75]
    ds_read_b128 v[184:187], v4 offset:20480
    v_mfma_f32_16x16x32_bf16 v[76:79], v[132:135], v[124:127], v[76:79]
    ds_read_b64_tr_b16 v[200:201], v8 offset:24576
    v_mfma_f32_16x16x32_bf16 v[80:83], v[112:115], v[136:139], v[80:83]
    ds_read_b64_tr_b16 v[202:203], v8 offset:25088
    v_mfma_f32_16x16x32_bf16 v[84:87], v[116:119], v[136:139], v[84:87]
    ds_read_b128 v[188:191], v4 offset:22528
    v_mfma_f32_16x16x32_bf16 v[96:99], v[120:123], v[136:139], v[96:99]
    ds_read_b64_tr_b16 v[204:205], v6 offset:24576
    v_mfma_f32_16x16x32_bf16 v[100:103], v[124:127], v[136:139], v[100:103]
    ds_read_b64_tr_b16 v[206:207], v6 offset:25088
    v_mfma_f32_16x16x32_bf16 v[88:91], v[112:115], v[140:143], v[88:91]
    ds_read_b128 v[208:211], v5 offset:16384
    v_mfma_f32_16x16x32_bf16 v[92:95], v[116:119], v[140:143], v[92:95]
    ds_read_b64_tr_b16 v[224:225], v8 offset:20480
    v_mfma_f32_16x16x32_bf16 v[104:107], v[120:123], v[140:143], v[104:107]
    ds_read_b64_tr_b16 v[226:227], v8 offset:20992
    v_mfma_f32_16x16x32_bf16 v[108:111], v[124:127], v[140:143], v[108:111]
    ds_read_b128 v[212:215], v5 offset:18432
    v_mfma_f32_16x16x32_bf16 v[48:51], v[160:163], v[144:147], v[48:51]
    ds_read_b64_tr_b16 v[228:229], v6 offset:20480
    v_mfma_f32_16x16x32_bf16 v[52:55], v[160:163], v[148:151], v[52:55]
    ds_read_b64_tr_b16 v[230:231], v6 offset:20992
    v_mfma_f32_16x16x32_bf16 v[64:67], v[160:163], v[152:155], v[64:67]
    ds_read_b128 v[216:219], v5 offset:20480
    v_mfma_f32_16x16x32_bf16 v[68:71], v[160:163], v[156:159], v[68:71]
    ds_read_b64_tr_b16 v[232:233], v8 offset:28672
    v_mfma_f32_16x16x32_bf16 v[56:59], v[164:167], v[144:147], v[56:59]
    ds_read_b64_tr_b16 v[234:235], v8 offset:29184
    v_mfma_f32_16x16x32_bf16 v[60:63], v[164:167], v[148:151], v[60:63]
    ds_read_b128 v[220:223], v5 offset:22528
    v_mfma_f32_16x16x32_bf16 v[72:75], v[164:167], v[152:155], v[72:75]
    ds_read_b64_tr_b16 v[236:237], v6 offset:28672
    v_mfma_f32_16x16x32_bf16 v[76:79], v[164:167], v[156:159], v[76:79]
    ds_read_b64_tr_b16 v[238:239], v6 offset:29184
    v_mfma_f32_16x16x32_bf16 v[80:83], v[144:147], v[168:171], v[80:83]
    v_mfma_f32_16x16x32_bf16 v[84:87], v[148:151], v[168:171], v[84:87]
    v_mfma_f32_16x16x32_bf16 v[96:99], v[152:155], v[168:171], v[96:99]
    v_mfma_f32_16x16x32_bf16 v[100:103], v[156:159], v[168:171], v[100:103]
    v_mfma_f32_16x16x32_bf16 v[88:91], v[144:147], v[172:175], v[88:91]
    v_mfma_f32_16x16x32_bf16 v[92:95], v[148:151], v[172:175], v[92:95]
    v_mfma_f32_16x16x32_bf16 v[104:107], v[152:155], v[172:175], v[104:107]
    v_mfma_f32_16x16x32_bf16 v[108:111], v[156:159], v[172:175], v[108:111]
    s_waitcnt lgkmcnt(0)
    s_barrier
    v_mfma_f32_16x16x32_bf16 v[48:51], v[192:195], v[176:179], v[48:51]
    ds_read_b128 v[112:115], v4 offset:32768
    v_mfma_f32_16x16x32_bf16 v[52:55], v[192:195], v[180:183], v[52:55]
    ds_read_b64_tr_b16 v[128:129], v8 offset:32768
    v_mfma_f32_16x16x32_bf16 v[64:67], v[192:195], v[184:187], v[64:67]
    ds_read_b64_tr_b16 v[130:131], v8 offset:33280
    v_mfma_f32_16x16x32_bf16 v[68:71], v[192:195], v[188:191], v[68:71]
    ds_read_b128 v[116:119], v4 offset:34816
    v_mfma_f32_16x16x32_bf16 v[56:59], v[196:199], v[176:179], v[56:59]
    ds_read_b64_tr_b16 v[132:133], v6 offset:32768
    v_mfma_f32_16x16x32_bf16 v[60:63], v[196:199], v[180:183], v[60:63]
    ds_read_b64_tr_b16 v[134:135], v6 offset:33280
    v_mfma_f32_16x16x32_bf16 v[72:75], v[196:199], v[184:187], v[72:75]
    ds_read_b128 v[120:123], v4 offset:36864
    v_mfma_f32_16x16x32_bf16 v[76:79], v[196:199], v[188:191], v[76:79]
    ds_read_b64_tr_b16 v[136:137], v8 offset:40960
    v_mfma_f32_16x16x32_bf16 v[80:83], v[176:179], v[200:203], v[80:83]
    ds_read_b64_tr_b16 v[138:139], v8 offset:41472
    v_mfma_f32_16x16x32_bf16 v[84:87], v[180:183], v[200:203], v[84:87]
    ds_read_b128 v[124:127], v4 offset:38912
    v_mfma_f32_16x16x32_bf16 v[96:99], v[184:187], v[200:203], v[96:99]
    ds_read_b64_tr_b16 v[140:141], v6 offset:40960
    v_mfma_f32_16x16x32_bf16 v[100:103], v[188:191], v[200:203], v[100:103]
    ds_read_b64_tr_b16 v[142:143], v6 offset:41472
    v_mfma_f32_16x16x32_bf16 v[88:91], v[176:179], v[204:207], v[88:91]
    ds_read_b128 v[144:147], v5 offset:32768
    v_mfma_f32_16x16x32_bf16 v[92:95], v[180:183], v[204:207], v[92:95]
    ds_read_b64_tr_b16 v[160:161], v8 offset:36864
    v_mfma_f32_16x16x32_bf16 v[104:107], v[184:187], v[204:207], v[104:107]
    ds_read_b64_tr_b16 v[162:163], v8 offset:37376
    v_mfma_f32_16x16x32_bf16 v[108:111], v[188:191], v[204:207], v[108:111]
    ds_read_b128 v[148:151], v5 offset:34816
    v_mfma_f32_16x16x32_bf16 v[48:51], v[224:227], v[208:211], v[48:51]
    ds_read_b64_tr_b16 v[164:165], v6 offset:36864
    v_mfma_f32_16x16x32_bf16 v[52:55], v[224:227], v[212:215], v[52:55]
    ds_read_b64_tr_b16 v[166:167], v6 offset:37376
    v_mfma_f32_16x16x32_bf16 v[64:67], v[224:227], v[216:219], v[64:67]
    ds_read_b128 v[152:155], v5 offset:36864
    v_mfma_f32_16x16x32_bf16 v[68:71], v[224:227], v[220:223], v[68:71]
    ds_read_b64_tr_b16 v[168:169], v8 offset:45056
    v_mfma_f32_16x16x32_bf16 v[56:59], v[228:231], v[208:211], v[56:59]
    ds_read_b64_tr_b16 v[170:171], v8 offset:45568
    v_mfma_f32_16x16x32_bf16 v[60:63], v[228:231], v[212:215], v[60:63]
    ds_read_b128 v[156:159], v5 offset:38912
    v_mfma_f32_16x16x32_bf16 v[72:75], v[228:231], v[216:219], v[72:75]
    ds_read_b64_tr_b16 v[172:173], v6 offset:45056
    v_mfma_f32_16x16x32_bf16 v[76:79], v[228:231], v[220:223], v[76:79]
    ds_read_b64_tr_b16 v[174:175], v6 offset:45568
    v_mfma_f32_16x16x32_bf16 v[80:83], v[208:211], v[232:235], v[80:83]
    v_mfma_f32_16x16x32_bf16 v[84:87], v[212:215], v[232:235], v[84:87]
    v_mfma_f32_16x16x32_bf16 v[96:99], v[216:219], v[232:235], v[96:99]
    v_mfma_f32_16x16x32_bf16 v[100:103], v[220:223], v[232:235], v[100:103]
    v_mfma_f32_16x16x32_bf16 v[88:91], v[208:211], v[236:239], v[88:91]
    v_mfma_f32_16x16x32_bf16 v[92:95], v[212:215], v[236:239], v[92:95]
    v_mfma_f32_16x16x32_bf16 v[104:107], v[216:219], v[236:239], v[104:107]
    v_mfma_f32_16x16x32_bf16 v[108:111], v[220:223], v[236:239], v[108:111]
    s_waitcnt lgkmcnt(0)
    s_barrier
    v_mfma_f32_16x16x32_bf16 v[48:51], v[128:131], v[112:115], v[48:51]
    ds_read_b128 v[176:179], v4 offset:49152
    v_mfma_f32_16x16x32_bf16 v[52:55], v[128:131], v[116:119], v[52:55]
    ds_read_b64_tr_b16 v[192:193], v8 offset:49152
    v_mfma_f32_16x16x32_bf16 v[64:67], v[128:131], v[120:123], v[64:67]
    ds_read_b64_tr_b16 v[194:195], v8 offset:49664
    v_mfma_f32_16x16x32_bf16 v[68:71], v[128:131], v[124:127], v[68:71]
    ds_read_b128 v[180:183], v4 offset:51200
    v_mfma_f32_16x16x32_bf16 v[56:59], v[132:135], v[112:115], v[56:59]
    ds_read_b64_tr_b16 v[196:197], v6 offset:49152
    v_mfma_f32_16x16x32_bf16 v[60:63], v[132:135], v[116:119], v[60:63]
    ds_read_b64_tr_b16 v[198:199], v6 offset:49664
    v_mfma_f32_16x16x32_bf16 v[72:75], v[132:135], v[120:123], v[72:75]
    ds_read_b128 v[184:187], v4 offset:53248
    v_mfma_f32_16x16x32_bf16 v[76:79], v[132:135], v[124:127], v[76:79]
    ds_read_b64_tr_b16 v[200:201], v8 offset:57344
    v_mfma_f32_16x16x32_bf16 v[80:83], v[112:115], v[136:139], v[80:83]
    ds_read_b64_tr_b16 v[202:203], v8 offset:57856
    v_mfma_f32_16x16x32_bf16 v[84:87], v[116:119], v[136:139], v[84:87]
    ds_read_b128 v[188:191], v4 offset:55296
    v_mfma_f32_16x16x32_bf16 v[96:99], v[120:123], v[136:139], v[96:99]
    ds_read_b64_tr_b16 v[204:205], v6 offset:57344
    v_mfma_f32_16x16x32_bf16 v[100:103], v[124:127], v[136:139], v[100:103]
    ds_read_b64_tr_b16 v[206:207], v6 offset:57856
    v_mfma_f32_16x16x32_bf16 v[88:91], v[112:115], v[140:143], v[88:91]
    ds_read_b128 v[208:211], v5 offset:49152
    v_mfma_f32_16x16x32_bf16 v[92:95], v[116:119], v[140:143], v[92:95]
    ds_read_b64_tr_b16 v[224:225], v8 offset:53248
    v_mfma_f32_16x16x32_bf16 v[104:107], v[120:123], v[140:143], v[104:107]
    ds_read_b64_tr_b16 v[226:227], v8 offset:53760
    v_mfma_f32_16x16x32_bf16 v[108:111], v[124:127], v[140:143], v[108:111]
    ds_read_b128 v[212:215], v5 offset:51200
    v_mfma_f32_16x16x32_bf16 v[48:51], v[160:163], v[144:147], v[48:51]
    ds_read_b64_tr_b16 v[228:229], v6 offset:53248
    v_mfma_f32_16x16x32_bf16 v[52:55], v[160:163], v[148:151], v[52:55]
    ds_read_b64_tr_b16 v[230:231], v6 offset:53760
    v_mfma_f32_16x16x32_bf16 v[64:67], v[160:163], v[152:155], v[64:67]
    ds_read_b128 v[216:219], v5 offset:53248
    v_mfma_f32_16x16x32_bf16 v[68:71], v[160:163], v[156:159], v[68:71]
    ds_read_b64_tr_b16 v[232:233], v8 offset:61440
    v_mfma_f32_16x16x32_bf16 v[56:59], v[164:167], v[144:147], v[56:59]
    ds_read_b64_tr_b16 v[234:235], v8 offset:61952
    v_mfma_f32_16x16x32_bf16 v[60:63], v[164:167], v[148:151], v[60:63]
    ds_read_b128 v[220:223], v5 offset:55296
    v_mfma_f32_16x16x32_bf16 v[72:75], v[164:167], v[152:155], v[72:75]
    ds_read_b64_tr_b16 v[236:237], v6 offset:61440
    v_mfma_f32_16x16x32_bf16 v[76:79], v[164:167], v[156:159], v[76:79]
    ds_read_b64_tr_b16 v[238:239], v6 offset:61952
    v_mfma_f32_16x16x32_bf16 v[80:83], v[144:147], v[168:171], v[80:83]
    v_mfma_f32_16x16x32_bf16 v[84:87], v[148:151], v[168:171], v[84:87]
    v_mfma_f32_16x16x32_bf16 v[96:99], v[152:155], v[168:171], v[96:99]
    v_mfma_f32_16x16x32_bf16 v[100:103], v[156:159], v[168:171], v[100:103]
    v_mfma_f32_16x16x32_bf16 v[88:91], v[144:147], v[172:175], v[88:91]
    v_mfma_f32_16x16x32_bf16 v[92:95], v[148:151], v[172:175], v[92:95]
    v_mfma_f32_16x16x32_bf16 v[104:107], v[152:155], v[172:175], v[104:107]
    v_mfma_f32_16x16x32_bf16 v[108:111], v[156:159], v[172:175], v[108:111]
    s_waitcnt lgkmcnt(0)
    s_barrier
    v_mfma_f32_16x16x32_bf16 v[48:51], v[192:195], v[176:179], v[48:51]
    v_xor_b32 v4, 0x10000, v4
    v_mfma_f32_16x16x32_bf16 v[52:55], v[192:195], v[180:183], v[52:55]
    v_xor_b32 v5, 0x10000, v5
    v_mfma_f32_16x16x32_bf16 v[64:67], v[192:195], v[184:187], v[64:67]
    s_xor_b32 s53, s69, 0
    v_mfma_f32_16x16x32_bf16 v[68:71], v[192:195], v[188:191], v[68:71]
    s_lshl_b32 s53, s53, 11
    v_mfma_f32_16x16x32_bf16 v[56:59], v[196:199], v[176:179], v[56:59]
    s_add_u32 s53, s53, 2097152
    v_mfma_f32_16x16x32_bf16 v[60:63], v[196:199], v[180:183], v[60:63]
    s_add_u32 s54, s53, 131072
    v_mfma_f32_16x16x32_bf16 v[72:75], v[196:199], v[184:187], v[72:75]
    s_xor_b32 s57, s69, 512
    v_mfma_f32_16x16x32_bf16 v[76:79], v[196:199], v[188:191], v[76:79]
    s_lshl_b32 s57, s57, 11
    v_mfma_f32_16x16x32_bf16 v[80:83], v[176:179], v[200:203], v[80:83]
    s_add_u32 s57, s57, 2097152
    v_mfma_f32_16x16x32_bf16 v[84:87], v[180:183], v[200:203], v[84:87]
    v_mfma_f32_16x16x32_bf16 v[96:99], v[184:187], v[200:203], v[96:99]
    v_mfma_f32_16x16x32_bf16 v[100:103], v[188:191], v[200:203], v[100:103]
    v_mfma_f32_16x16x32_bf16 v[88:91], v[176:179], v[204:207], v[88:91]
    v_mfma_f32_16x16x32_bf16 v[92:95], v[180:183], v[204:207], v[92:95]
    v_mfma_f32_16x16x32_bf16 v[104:107], v[184:187], v[204:207], v[104:107]
    v_mfma_f32_16x16x32_bf16 v[108:111], v[188:191], v[204:207], v[108:111]
    v_mfma_f32_16x16x32_bf16 v[48:51], v[224:227], v[208:211], v[48:51]
    v_mfma_f32_16x16x32_bf16 v[52:55], v[224:227], v[212:215], v[52:55]
    v_mfma_f32_16x16x32_bf16 v[64:67], v[224:227], v[216:219], v[64:67]
    v_mfma_f32_16x16x32_bf16 v[68:71], v[224:227], v[220:223], v[68:71]
    v_mfma_f32_16x16x32_bf16 v[56:59], v[228:231], v[208:211], v[56:59]
    v_mfma_f32_16x16x32_bf16 v[60:63], v[228:231], v[212:215], v[60:63]
    v_mfma_f32_16x16x32_bf16 v[72:75], v[228:231], v[216:219], v[72:75]
    v_mfma_f32_16x16x32_bf16 v[76:79], v[228:231], v[220:223], v[76:79]
    v_mfma_f32_16x16x32_bf16 v[80:83], v[208:211], v[232:235], v[80:83]
    v_mfma_f32_16x16x32_bf16 v[84:87], v[212:215], v[232:235], v[84:87]
    v_mfma_f32_16x16x32_bf16 v[96:99], v[216:219], v[232:235], v[96:99]
    v_mfma_f32_16x16x32_bf16 v[100:103], v[220:223], v[232:235], v[100:103]
    v_mfma_f32_16x16x32_bf16 v[88:91], v[208:211], v[236:239], v[88:91]
    v_mfma_f32_16x16x32_bf16 v[92:95], v[212:215], v[236:239], v[92:95]
    v_mfma_f32_16x16x32_bf16 v[104:107], v[216:219], v[236:239], v[104:107]
    v_mfma_f32_16x16x32_bf16 v[108:111], v[220:223], v[236:239], v[108:111]
    s_nop 3
    s_add_u32 s58, s57, 131072
    v_cvt_pk_bf16_f32 v16, v48, v49
    v_cvt_pk_bf16_f32 v17, v50, v51
    v_cvt_pk_bf16_f32 v18, v52, v53
    v_cvt_pk_bf16_f32 v19, v54, v55
    v_cvt_pk_bf16_f32 v20, v56, v57
    v_cvt_pk_bf16_f32 v21, v58, v59
    v_cvt_pk_bf16_f32 v22, v60, v61
    v_cvt_pk_bf16_f32 v23, v62, v63
    v_permlane16_swap_b32 v16, v18
    v_permlane16_swap_b32 v17, v19
    v_permlane16_swap_b32 v20, v22
    v_permlane16_swap_b32 v21, v23
    buffer_store_dwordx4 v[16:19], v1, s[40:43], s53 offen offset:0 sc1
    buffer_store_dwordx4 v[20:23], v1, s[40:43], s54 offen offset:0 sc1
    v_cvt_pk_bf16_f32 v24, v64, v65
    v_cvt_pk_bf16_f32 v25, v66, v67
    v_cvt_pk_bf16_f32 v26, v68, v69
    v_cvt_pk_bf16_f32 v27, v70, v71
    v_cvt_pk_bf16_f32 v28, v72, v73
    v_cvt_pk_bf16_f32 v29, v74, v75
    v_cvt_pk_bf16_f32 v30, v76, v77
    v_cvt_pk_bf16_f32 v31, v78, v79
    v_permlane16_swap_b32 v24, v26
    v_permlane16_swap_b32 v25, v27
    v_permlane16_swap_b32 v28, v30
    v_permlane16_swap_b32 v29, v31
    buffer_store_dwordx4 v[24:27], v1, s[40:43], s53 offen offset:2048 sc1
    buffer_store_dwordx4 v[28:31], v1, s[40:43], s54 offen offset:2048 sc1
    v_cvt_pk_bf16_f32 v32, v80, v81
    v_cvt_pk_bf16_f32 v33, v82, v83
    v_cvt_pk_bf16_f32 v34, v84, v85
    v_cvt_pk_bf16_f32 v35, v86, v87
    v_cvt_pk_bf16_f32 v36, v88, v89
    v_cvt_pk_bf16_f32 v37, v90, v91
    v_cvt_pk_bf16_f32 v38, v92, v93
    v_cvt_pk_bf16_f32 v39, v94, v95
    v_permlane16_swap_b32 v32, v34
    v_permlane16_swap_b32 v33, v35
    v_permlane16_swap_b32 v36, v38
    v_permlane16_swap_b32 v37, v39
    buffer_store_dwordx4 v[32:35], v1, s[40:43], s57 offen offset:1024 sc1
    buffer_store_dwordx4 v[36:39], v1, s[40:43], s58 offen offset:1024 sc1
    v_cvt_pk_bf16_f32 v40, v96, v97
    v_cvt_pk_bf16_f32 v41, v98, v99
    v_cvt_pk_bf16_f32 v42, v100, v101
    v_cvt_pk_bf16_f32 v43, v102, v103
    v_cvt_pk_bf16_f32 v44, v104, v105
    v_cvt_pk_bf16_f32 v45, v106, v107
    v_cvt_pk_bf16_f32 v46, v108, v109
    v_cvt_pk_bf16_f32 v47, v110, v111
    v_permlane16_swap_b32 v40, v42
    v_permlane16_swap_b32 v41, v43
    v_permlane16_swap_b32 v44, v46
    v_permlane16_swap_b32 v45, v47
    buffer_store_dwordx4 v[40:43], v1, s[40:43], s57 offen offset:3072 sc1
    buffer_store_dwordx4 v[44:47], v1, s[40:43], s58 offen offset:3072 sc1
    global_load_dword v10, v3, s[22:23] sc1
.p2align 3
    s_barrier
    s_nop 0
    ds_read_b128 v[112:115], v4 offset:0
    ds_read_b64_tr_b16 v[128:129], v8 offset:32768
    ds_read_b128 v[116:119], v4 offset:2048
    ds_read_b64_tr_b16 v[130:131], v8 offset:33280
    ds_read_b128 v[120:123], v4 offset:4096
    ds_read_b64_tr_b16 v[132:133], v6 offset:32768
    ds_read_b128 v[124:127], v4 offset:6144
    ds_read_b64_tr_b16 v[134:135], v6 offset:33280
    ds_read_b128 v[144:147], v5 offset:0
    ds_read_b64_tr_b16 v[160:161], v8 offset:36864
    ds_read_b128 v[148:151], v5 offset:2048
    ds_read_b64_tr_b16 v[162:163], v8 offset:37376
    ds_read_b128 v[152:155], v5 offset:4096
    ds_read_b64_tr_b16 v[164:165], v6 offset:36864
    ds_read_b128 v[156:159], v5 offset:6144
    ds_read_b64_tr_b16 v[166:167], v6 offset:37376
    s_waitcnt lgkmcnt(0)
    s_barrier
    v_mfma_f32_16x16x32_bf16 v[48:51], v[128:131], v[112:115], 0
    ds_read_b128 v[176:179], v4 offset:16384
    ds_read_b64_tr_b16 v[192:193], v8 offset:40960
    v_mfma_f32_16x16x32_bf16 v[52:55], v[128:131], v[116:119], 0
    ds_read_b128 v[180:183], v4 offset:18432
    ds_read_b64_tr_b16 v[194:195], v8 offset:41472
    v_mfma_f32_16x16x32_bf16 v[64:67], v[128:131], v[120:123], 0
    ds_read_b128 v[184:187], v4 offset:20480
    ds_read_b64_tr_b16 v[196:197], v6 offset:40960
    v_mfma_f32_16x16x32_bf16 v[68:71], v[128:131], v[124:127], 0
    ds_read_b128 v[188:191], v4 offset:22528
    ds_read_b64_tr_b16 v[198:199], v6 offset:41472
    v_mfma_f32_16x16x32_bf16 v[56:59], v[132:135], v[112:115], 0
    ds_read_b128 v[208:211], v5 offset:16384
    ds_read_b64_tr_b16 v[224:225], v8 offset:45056
    v_mfma_f32_16x16x32_bf16 v[60:63], v[132:135], v[116:119], 0
    ds_read_b128 v[212:215], v5 offset:18432
    ds_read_b64_tr_b16 v[226:227], v8 offset:45568
    v_mfma_f32_16x16x32_bf16 v[72:75], v[132:135], v[120:123], 0
    ds_read_b128 v[216:219], v5 offset:20480
    ds_read_b64_tr_b16 v[228:229], v6 offset:45056
    v_mfma_f32_16x16x32_bf16 v[76:79], v[132:135], v[124:127], 0
    ds_read_b128 v[220:223], v5 offset:22528
    ds_read_b64_tr_b16 v[230:231], v6 offset:45568
    v_mfma_f32_16x16x32_bf16 v[48:51], v[160:163], v[144:147], v[48:51]
    v_mfma_f32_16x16x32_bf16 v[52:55], v[160:163], v[148:151], v[52:55]
    v_mfma_f32_16x16x32_bf16 v[64:67], v[160:163], v[152:155], v[64:67]
    v_mfma_f32_16x16x32_bf16 v[68:71], v[160:163], v[156:159], v[68:71]
    v_mfma_f32_16x16x32_bf16 v[56:59], v[164:167], v[144:147], v[56:59]
    v_mfma_f32_16x16x32_bf16 v[60:63], v[164:167], v[148:151], v[60:63]
    v_mfma_f32_16x16x32_bf16 v[72:75], v[164:167], v[152:155], v[72:75]
    v_mfma_f32_16x16x32_bf16 v[76:79], v[164:167], v[156:159], v[76:79]
    s_waitcnt lgkmcnt(0) vmcnt(0)
    s_barrier
    s_cmp_lg_u32 s48, 0
    s_cbranch_scc1 L_drained0
    v_readfirstlane_b32 s58, v10
    s_mov_b32 s52, 20056064
    s_cmp_eq_u32 s58, 0
    s_cbranch_scc1 L_sig1
L_initok0:
    s_mov_b64 exec, 5
    buffer_atomic_add v15, v14, s[40:43], s52 offen sc1
    s_mov_b64 exec, -1
    s_nop 0
L_drained0:
    v_mfma_f32_16x16x32_bf16 v[48:51], v[192:195], v[176:179], v[48:51]
    ds_read_b128 v[112:115], v4 offset:32768
    ds_read_b64_tr_b16 v[128:129], v8 offset:49152
    v_mfma_f32_16x16x32_bf16 v[52:55], v[192:195], v[180:183], v[52:55]
    ds_read_b128 v[116:119], v4 offset:34816
    ds_read_b64_tr_b16 v[130:131], v8 offset:49664
    v_mfma_f32_16x16x32_bf16 v[64:67], v[192:195], v[184:187], v[64:67]
    ds_read_b128 v[120:123], v4 offset:36864
    ds_read_b64_tr_b16 v[132:133], v6 offset:49152
    v_mfma_f32_16x16x32_bf16 v[68:71], v[192:195], v[188:191], v[68:71]
    ds_read_b128 v[124:127], v4 offset:38912
    ds_read_b64_tr_b16 v[134:135], v6 offset:49664
    v_mfma_f32_16x16x32_bf16 v[56:59], v[196:199], v[176:179], v[56:59]
    ds_read_b128 v[144:147], v5 offset:32768
    ds_read_b64_tr_b16 v[160:161], v8 offset:53248
    v_mfma_f32_16x16x32_bf16 v[60:63], v[196:199], v[180:183], v[60:63]
    ds_read_b128 v[148:151], v5 offset:34816
    ds_read_b64_tr_b16 v[162:163], v8 offset:53760
    v_mfma_f32_16x16x32_bf16 v[72:75], v[196:199], v[184:187], v[72:75]
    ds_read_b128 v[152:155], v5 offset:36864
    ds_read_b64_tr_b16 v[164:165], v6 offset:53248
    v_mfma_f32_16x16x32_bf16 v[76:79], v[196:199], v[188:191], v[76:79]
    ds_read_b128 v[156:159], v5 offset:38912
    ds_read_b64_tr_b16 v[166:167], v6 offset:53760
    v_mfma_f32_16x16x32_bf16 v[48:51], v[224:227], v[208:211], v[48:51]
    v_mfma_f32_16x16x32_bf16 v[52:55], v[224:227], v[212:215], v[52:55]
    v_mfma_f32_16x16x32_bf16 v[64:67], v[224:227], v[216:219], v[64:67]
    v_mfma_f32_16x16x32_bf16 v[68:71], v[224:227], v[220:223], v[68:71]
    v_mfma_f32_16x16x32_bf16 v[56:59], v[228:231], v[208:211], v[56:59]
    v_mfma_f32_16x16x32_bf16 v[60:63], v[228:231], v[212:215], v[60:63]
    v_mfma_f32_16x16x32_bf16 v[72:75], v[228:231], v[216:219], v[72:75]
    v_mfma_f32_16x16x32_bf16 v[76:79], v[228:231], v[220:223], v[76:79]
    s_waitcnt lgkmcnt(0)
    s_barrier
    s_mov_b32 m0, s32
    s_nop 0
    buffer_load_dwordx4 v1, s[44:47], s36 offen lds
    v_mfma_f32_16x16x32_bf16 v[48:51], v[128:131], v[112:115], v[48:51]
    ds_read_b128 v[176:179], v4 offset:49152
    ds_read_b64_tr_b16 v[192:193], v8 offset:57344
    v_mfma_f32_16x16x32_bf16 v[52:55], v[128:131], v[116:119], v[52:55]
    ds_read_b128 v[180:183], v4 offset:51200
    ds_read_b64_tr_b16 v[194:195], v8 offset:57856
    v_mfma_f32_16x16x32_bf16 v[64:67], v[128:131], v[120:123], v[64:67]
    ds_read_b128 v[184:187], v4 offset:53248
    ds_read_b64_tr_b16 v[196:197], v6 offset:57344
    v_mfma_f32_16x16x32_bf16 v[68:71], v[128:131], v[124:127], v[68:71]
    ds_read_b128 v[188:191], v4 offset:55296
    ds_read_b64_tr_b16 v[198:199], v6 offset:57856
    v_mfma_f32_16x16x32_bf16 v[56:59], v[132:135], v[112:115], v[56:59]
    ds_read_b128 v[208:211], v5 offset:49152
    ds_read_b64_tr_b16 v[224:225], v8 offset:61440
    v_mfma_f32_16x16x32_bf16 v[60:63], v[132:135], v[116:119], v[60:63]
    ds_read_b128 v[212:215], v5 offset:51200
    ds_read_b64_tr_b16 v[226:227], v8 offset:61952
    v_mfma_f32_16x16x32_bf16 v[72:75], v[132:135], v[120:123], v[72:75]
    ds_read_b128 v[216:219], v5 offset:53248
    ds_read_b64_tr_b16 v[228:229], v6 offset:61440
    v_mfma_f32_16x16x32_bf16 v[76:79], v[132:135], v[124:127], v[76:79]
    ds_read_b128 v[220:223], v5 offset:55296
    ds_read_b64_tr_b16 v[230:231], v6 offset:61952
    v_mfma_f32_16x16x32_bf16 v[48:51], v[160:163], v[144:147], v[48:51]
    v_mfma_f32_16x16x32_bf16 v[52:55], v[160:163], v[148:151], v[52:55]
    v_mfma_f32_16x16x32_bf16 v[64:67], v[160:163], v[152:155], v[64:67]
    v_mfma_f32_16x16x32_bf16 v[68:71], v[160:163], v[156:159], v[68:71]
    v_mfma_f32_16x16x32_bf16 v[56:59], v[164:167], v[144:147], v[56:59]
    v_mfma_f32_16x16x32_bf16 v[60:63], v[164:167], v[148:151], v[60:63]
    v_mfma_f32_16x16x32_bf16 v[72:75], v[164:167], v[152:155], v[72:75]
    v_mfma_f32_16x16x32_bf16 v[76:79], v[164:167], v[156:159], v[76:79]
    s_waitcnt lgkmcnt(0)
    s_barrier
    v_mfma_f32_16x16x32_bf16 v[48:51], v[192:195], v[176:179], v[48:51]
    v_xor_b32 v4, 0x10000, v4
    v_xor_b32 v5, 0x10000, v5
    v_mfma_f32_16x16x32_bf16 v[52:55], v[192:195], v[180:183], v[52:55]
    ds_read_b128 v[112:115], v4 offset:0
    ds_read_b64_tr_b16 v[128:129], v8 offset:32768
    v_mfma_f32_16x16x32_bf16 v[64:67], v[192:195], v[184:187], v[64:67]
    ds_read_b128 v[116:119], v4 offset:2048
    ds_read_b64_tr_b16 v[130:131], v8 offset:33280
    v_mfma_f32_16x16x32_bf16 v[68:71], v[192:195], v[188:191], v[68:71]
    ds_read_b128 v[120:123], v4 offset:4096
    ds_read_b64_tr_b16 v[132:133], v6 offset:32768
    v_mfma_f32_16x16x32_bf16 v[56:59], v[196:199], v[176:179], v[56:59]
    ds_read_b128 v[124:127], v4 offset:6144
    ds_read_b64_tr_b16 v[134:135], v6 offset:33280
    v_mfma_f32_16x16x32_bf16 v[60:63], v[196:199], v[180:183], v[60:63]
    ds_read_b128 v[144:147], v5 offset:0
    ds_read_b64_tr_b16 v[160:161], v8 offset:36864
    v_mfma_f32_16x16x32_bf16 v[72:75], v[196:199], v[184:187], v[72:75]
    ds_read_b128 v[148:151], v5 offset:2048
    ds_read_b64_tr_b16 v[162:163], v8 offset:37376
    v_mfma_f32_16x16x32_bf16 v[76:79], v[196:199], v[188:191], v[76:79]
    ds_read_b128 v[152:155], v5 offset:4096
    ds_read_b64_tr_b16 v[164:165], v6 offset:36864
    v_mfma_f32_16x16x32_bf16 v[48:51], v[224:227], v[208:211], v[48:51]
    ds_read_b128 v[156:159], v5 offset:6144
    ds_read_b64_tr_b16 v[166:167], v6 offset:37376
    v_mfma_f32_16x16x32_bf16 v[52:55], v[224:227], v[212:215], v[52:55]
    v_mfma_f32_16x16x32_bf16 v[64:67], v[224:227], v[216:219], v[64:67]
    v_mfma_f32_16x16x32_bf16 v[68:71], v[224:227], v[220:223], v[68:71]
    v_mfma_f32_16x16x32_bf16 v[56:59], v[228:231], v[208:211], v[56:59]
    v_mfma_f32_16x16x32_bf16 v[60:63], v[228:231], v[212:215], v[60:63]
    v_mfma_f32_16x16x32_bf16 v[72:75], v[228:231], v[216:219], v[72:75]
    v_mfma_f32_16x16x32_bf16 v[76:79], v[228:231], v[220:223], v[76:79]
    s_waitcnt lgkmcnt(0)
    s_barrier
    v_mfma_f32_16x16x32_bf16 v[48:51], v[128:131], v[112:115], v[48:51]
    ds_read_b128 v[176:179], v4 offset:16384
    ds_read_b64_tr_b16 v[192:193], v8 offset:40960
    v_mfma_f32_16x16x32_bf16 v[52:55], v[128:131], v[116:119], v[52:55]
    ds_read_b128 v[180:183], v4 offset:18432
    ds_read_b64_tr_b16 v[194:195], v8 offset:41472
    v_mfma_f32_16x16x32_bf16 v[64:67], v[128:131], v[120:123], v[64:67]
    ds_read_b128 v[184:187], v4 offset:20480
    ds_read_b64_tr_b16 v[196:197], v6 offset:40960
    v_mfma_f32_16x16x32_bf16 v[68:71], v[128:131], v[124:127], v[68:71]
    ds_read_b128 v[188:191], v4 offset:22528
    ds_read_b64_tr_b16 v[198:199], v6 offset:41472
    v_mfma_f32_16x16x32_bf16 v[56:59], v[132:135], v[112:115], v[56:59]
    ds_read_b128 v[208:211], v5 offset:16384
    ds_read_b64_tr_b16 v[224:225], v8 offset:45056
    v_mfma_f32_16x16x32_bf16 v[60:63], v[132:135], v[116:119], v[60:63]
    ds_read_b128 v[212:215], v5 offset:18432
    ds_read_b64_tr_b16 v[226:227], v8 offset:45568
    v_mfma_f32_16x16x32_bf16 v[72:75], v[132:135], v[120:123], v[72:75]
    ds_read_b128 v[216:219], v5 offset:20480
    ds_read_b64_tr_b16 v[228:229], v6 offset:45056
    v_mfma_f32_16x16x32_bf16 v[76:79], v[132:135], v[124:127], v[76:79]
    ds_read_b128 v[220:223], v5 offset:22528
    ds_read_b64_tr_b16 v[230:231], v6 offset:45568
    v_mfma_f32_16x16x32_bf16 v[48:51], v[160:163], v[144:147], v[48:51]
    v_mfma_f32_16x16x32_bf16 v[52:55], v[160:163], v[148:151], v[52:55]
    v_mfma_f32_16x16x32_bf16 v[64:67], v[160:163], v[152:155], v[64:67]
    v_mfma_f32_16x16x32_bf16 v[68:71], v[160:163], v[156:159], v[68:71]
    v_mfma_f32_16x16x32_bf16 v[56:59], v[164:167], v[144:147], v[56:59]
    v_mfma_f32_16x16x32_bf16 v[60:63], v[164:167], v[148:151], v[60:63]
    v_mfma_f32_16x16x32_bf16 v[72:75], v[164:167], v[152:155], v[72:75]
    v_mfma_f32_16x16x32_bf16 v[76:79], v[164:167], v[156:159], v[76:79]
    s_waitcnt lgkmcnt(0)
    s_barrier
    v_mfma_f32_16x16x32_bf16 v[48:51], v[192:195], v[176:179], v[48:51]
    ds_read_b128 v[112:115], v4 offset:32768
    ds_read_b64_tr_b16 v[128:129], v8 offset:49152
    v_mfma_f32_16x16x32_bf16 v[52:55], v[192:195], v[180:183], v[52:55]
    ds_read_b128 v[116:119], v4 offset:34816
    ds_read_b64_tr_b16 v[130:131], v8 offset:49664
    v_mfma_f32_16x16x32_bf16 v[64:67], v[192:195], v[184:187], v[64:67]
    ds_read_b128 v[120:123], v4 offset:36864
    ds_read_b64_tr_b16 v[132:133], v6 offset:49152
    v_mfma_f32_16x16x32_bf16 v[68:71], v[192:195], v[188:191], v[68:71]
    ds_read_b128 v[124:127], v4 offset:38912
    ds_read_b64_tr_b16 v[134:135], v6 offset:49664
    v_mfma_f32_16x16x32_bf16 v[56:59], v[196:199], v[176:179], v[56:59]
    ds_read_b128 v[144:147], v5 offset:32768
    ds_read_b64_tr_b16 v[160:161], v8 offset:53248
    v_mfma_f32_16x16x32_bf16 v[60:63], v[196:199], v[180:183], v[60:63]
    ds_read_b128 v[148:151], v5 offset:34816
    ds_read_b64_tr_b16 v[162:163], v8 offset:53760
    v_mfma_f32_16x16x32_bf16 v[72:75], v[196:199], v[184:187], v[72:75]
    ds_read_b128 v[152:155], v5 offset:36864
    ds_read_b64_tr_b16 v[164:165], v6 offset:53248
    v_mfma_f32_16x16x32_bf16 v[76:79], v[196:199], v[188:191], v[76:79]
    ds_read_b128 v[156:159], v5 offset:38912
    ds_read_b64_tr_b16 v[166:167], v6 offset:53760
    v_mfma_f32_16x16x32_bf16 v[48:51], v[224:227], v[208:211], v[48:51]
    s_waitcnt vmcnt(0)
    s_nop 0
    v_mfma_f32_16x16x32_bf16 v[52:55], v[224:227], v[212:215], v[52:55]
    ds_read_b64_tr_b16 v[248:249], v12 offset:0
    ds_read_b64_tr_b16 v[250:251], v12 offset:128
    v_mfma_f32_16x16x32_bf16 v[64:67], v[224:227], v[216:219], v[64:67]
    ds_read_b64_tr_b16 v[252:253], v12 offset:512
    ds_read_b64_tr_b16 v[254:255], v12 offset:640
    v_mfma_f32_16x16x32_bf16 v[68:71], v[224:227], v[220:223], v[68:71]
    v_mfma_f32_16x16x32_bf16 v[56:59], v[228:231], v[208:211], v[56:59]
    v_mfma_f32_16x16x32_bf16 v[60:63], v[228:231], v[212:215], v[60:63]
    v_mfma_f32_16x16x32_bf16 v[72:75], v[228:231], v[216:219], v[72:75]
    v_mfma_f32_16x16x32_bf16 v[76:79], v[228:231], v[220:223], v[76:79]
    s_waitcnt lgkmcnt(0)
    s_barrier
    v_mfma_f32_16x16x32_bf16 v[48:51], v[128:131], v[112:115], v[48:51]
    ds_read_b128 v[176:179], v4 offset:49152
    ds_read_b64_tr_b16 v[192:193], v8 offset:57344
    v_mfma_f32_16x16x32_bf16 v[52:55], v[128:131], v[116:119], v[52:55]
    ds_read_b128 v[180:183], v4 offset:51200
    ds_read_b64_tr_b16 v[194:195], v8 offset:57856
    v_mfma_f32_16x16x32_bf16 v[64:67], v[128:131], v[120:123], v[64:67]
    ds_read_b128 v[184:187], v4 offset:53248
    ds_read_b64_tr_b16 v[196:197], v6 offset:57344
    v_mfma_f32_16x16x32_bf16 v[68:71], v[128:131], v[124:127], v[68:71]
    ds_read_b128 v[188:191], v4 offset:55296
    ds_read_b64_tr_b16 v[198:199], v6 offset:57856
    v_mfma_f32_16x16x32_bf16 v[56:59], v[132:135], v[112:115], v[56:59]
    ds_read_b128 v[208:211], v5 offset:49152
    ds_read_b64_tr_b16 v[224:225], v8 offset:61440
    v_mfma_f32_16x16x32_bf16 v[60:63], v[132:135], v[116:119], v[60:63]
    ds_read_b128 v[212:215], v5 offset:51200
    ds_read_b64_tr_b16 v[226:227], v8 offset:61952
    v_mfma_f32_16x16x32_bf16 v[72:75], v[132:135], v[120:123], v[72:75]
    ds_read_b128 v[216:219], v5 offset:53248
    ds_read_b64_tr_b16 v[228:229], v6 offset:61440
    v_mfma_f32_16x16x32_bf16 v[76:79], v[132:135], v[124:127], v[76:79]
    ds_read_b128 v[220:223], v5 offset:55296
    ds_read_b64_tr_b16 v[230:231], v6 offset:61952
    v_mfma_f32_16x16x32_bf16 v[48:51], v[160:163], v[144:147], v[48:51]
    v_xor_b32 v248, v13, v248
    v_xor_b32 v249, v13, v249
    v_mfma_f32_16x16x32_bf16 v[52:55], v[160:163], v[148:151], v[52:55]
    v_xor_b32 v250, v13, v250
    v_xor_b32 v251, v13, v251
    v_mfma_f32_16x16x32_bf16 v[64:67], v[160:163], v[152:155], v[64:67]
    v_xor_b32 v252, v13, v252
    v_xor_b32 v253, v13, v253
    v_mfma_f32_16x16x32_bf16 v[68:71], v[160:163], v[156:159], v[68:71]
    v_xor_b32 v254, v13, v254
    v_xor_b32 v255, v13, v255
    v_mfma_f32_16x16x32_bf16 v[56:59], v[164:167], v[144:147], v[56:59]
    v_mfma_f32_16x16x32_bf16 v[60:63], v[164:167], v[148:151], v[60:63]
    v_mfma_f32_16x16x32_bf16 v[72:75], v[164:167], v[152:155], v[72:75]
    v_mfma_f32_16x16x32_bf16 v[76:79], v[164:167], v[156:159], v[76:79]
    s_waitcnt lgkmcnt(0)
    s_nop 0
    v_mfma_f32_16x16x32_bf16 v[48:51], v[192:195], v[176:179], v[48:51]
    v_mov_b32 v36, 0xdddddddd
    v_and_b32 v39, 27, v0
    v_mfma_f32_16x16x32_bf16 v[52:55], v[192:195], v[180:183], v[52:55]
    v_cmp_eq_u32 vcc, 16, v39
    v_mov_b32 v38, 0x3f803f80
    v_mfma_f32_16x16x32_bf16 v[64:67], v[192:195], v[184:187], v[64:67]
    v_mov_b64 v[44:45], -1
    v_cndmask_b32 v38, 0, v38, vcc
    v_mfma_f32_16x16x32_bf16 v[68:71], v[192:195], v[188:191], v[68:71]
    v_mov_b64 v[46:47], -1
    v_mov_b32 v39, v38
    v_mfma_f32_16x16x32_bf16 v[56:59], v[196:199], v[176:179], v[56:59]
    v_mov_b64 v[20:21], v[38:39]
    v_mov_b64 v[22:23], v[38:39]
    v_mfma_f32_16x16x32_bf16 v[60:63], v[196:199], v[180:183], v[60:63]
    v_mov_b64 v[24:25], v[38:39]
    v_mov_b64 v[26:27], v[38:39]
    v_mfma_f32_16x16x32_bf16 v[72:75], v[196:199], v[184:187], v[72:75]
    v_mov_b64 v[28:29], v[38:39]
    v_mov_b64 v[30:31], v[38:39]
    v_mfma_f32_16x16x32_bf16 v[76:79], v[196:199], v[188:191], v[76:79]
    v_mov_b64 v[32:33], v[38:39]
    v_mov_b64 v[34:35], v[38:39]
    v_mfma_f32_16x16x32_bf16 v[48:51], v[224:227], v[208:211], v[48:51]
    v_mov_b64 v[112:113], 0
    v_mov_b64 v[114:115], 0
    v_mfma_f32_16x16x32_bf16 v[52:55], v[224:227], v[212:215], v[52:55]
    v_mov_b64 v[116:117], 0
    v_mov_b64 v[118:119], 0
    v_mfma_f32_16x16x32_bf16 v[64:67], v[224:227], v[216:219], v[64:67]
    v_mov_b64 v[120:121], 0
    v_mov_b64 v[122:123], 0
    v_mfma_f32_16x16x32_bf16 v[68:71], v[224:227], v[220:223], v[68:71]
    v_mov_b64 v[124:125], 0
    v_mov_b64 v[126:127], 0
    v_mfma_f32_16x16x32_bf16 v[56:59], v[228:231], v[208:211], v[56:59]
    v_mov_b64 v[128:129], 0
    v_mov_b64 v[130:131], 0
    v_mfma_f32_16x16x32_bf16 v[60:63], v[228:231], v[212:215], v[60:63]
    v_mov_b64 v[132:133], 0
    v_mov_b64 v[134:135], 0
    v_mfma_f32_16x16x32_bf16 v[72:75], v[228:231], v[216:219], v[72:75]
    v_mov_b64 v[136:137], 0
    v_mov_b64 v[138:139], 0
    v_mfma_f32_16x16x32_bf16 v[76:79], v[228:231], v[220:223], v[76:79]
    v_mov_b64 v[140:141], 0
    v_mov_b64 v[142:143], 0
    v_add_u32 v37, 69632, v1
    v_mov_b64 v[42:43], 0
    s_branch L_epiB
.p2align 3
L_cmp1:
    s_barrier
    s_nop 0
    ds_read_b128 v[112:115], v4 offset:0
    ds_read_b64_tr_b16 v[128:129], v8 offset:32768
    ds_read_b128 v[116:119], v4 offset:2048
    ds_read_b64_tr_b16 v[130:131], v8 offset:33280
    ds_read_b128 v[120:123], v4 offset:4096
    ds_read_b64_tr_b16 v[132:133], v6 offset:32768
    ds_read_b128 v[124:127], v4 offset:6144
    ds_read_b64_tr_b16 v[134:135], v6 offset:33280
    ds_read_b128 v[144:147], v5 offset:0
    ds_read_b64_tr_b16 v[160:161], v8 offset:36864
    ds_read_b128 v[148:151], v5 offset:2048
    ds_read_b64_tr_b16 v[162:163], v8 offset:37376
    ds_read_b128 v[152:155], v5 offset:4096
    ds_read_b64_tr_b16 v[164:165], v6 offset:36864
    ds_read_b128 v[156:159], v5 offset:6144
    ds_read_b64_tr_b16 v[166:167], v6 offset:37376
    s_waitcnt lgkmcnt(0)
    s_barrier
    v_mfma_f32_16x16x32_bf16 v[48:51], v[128:131], v[112:115], 0
    ds_read_b128 v[176:179], v4 offset:16384
    ds_read_b64_tr_b16 v[192:193], v8 offset:40960
    v_mfma_f32_16x16x32_bf16 v[52:55], v[128:131], v[116:119], 0
    ds_read_b128 v[180:183], v4 offset:18432
    ds_read_b64_tr_b16 v[194:195], v8 offset:41472
    v_mfma_f32_16x16x32_bf16 v[64:67], v[128:131], v[120:123], 0
    ds_read_b128 v[184:187], v4 offset:20480
    ds_read_b64_tr_b16 v[196:197], v6 offset:40960
    v_mfma_f32_16x16x32_bf16 v[68:71], v[128:131], v[124:127], 0
    ds_read_b128 v[188:191], v4 offset:22528
    ds_read_b64_tr_b16 v[198:199], v6 offset:41472
    v_mfma_f32_16x16x32_bf16 v[56:59], v[132:135], v[112:115], 0
    ds_read_b128 v[208:211], v5 offset:16384
    ds_read_b64_tr_b16 v[224:225], v8 offset:45056
    v_mfma_f32_16x16x32_bf16 v[60:63], v[132:135], v[116:119], 0
    ds_read_b128 v[212:215], v5 offset:18432
    ds_read_b64_tr_b16 v[226:227], v8 offset:45568
    v_mfma_f32_16x16x32_bf16 v[72:75], v[132:135], v[120:123], 0
    ds_read_b128 v[216:219], v5 offset:20480
    ds_read_b64_tr_b16 v[228:229], v6 offset:45056
    v_mfma_f32_16x16x32_bf16 v[76:79], v[132:135], v[124:127], 0
    ds_read_b128 v[220:223], v5 offset:22528
    ds_read_b64_tr_b16 v[230:231], v6 offset:45568
    v_mfma_f32_16x16x32_bf16 v[48:51], v[160:163], v[144:147], v[48:51]
    v_mfma_f32_16x16x32_bf16 v[52:55], v[160:163], v[148:151], v[52:55]
    v_mfma_f32_16x16x32_bf16 v[64:67], v[160:163], v[152:155], v[64:67]
    v_mfma_f32_16x16x32_bf16 v[68:71], v[160:163], v[156:159], v[68:71]
    v_mfma_f32_16x16x32_bf16 v[56:59], v[164:167], v[144:147], v[56:59]
    v_mfma_f32_16x16x32_bf16 v[60:63], v[164:167], v[148:151], v[60:63]
    v_mfma_f32_16x16x32_bf16 v[72:75], v[164:167], v[152:155], v[72:75]
    v_mfma_f32_16x16x32_bf16 v[76:79], v[164:167], v[156:159], v[76:79]
    s_waitcnt lgkmcnt(0)
    s_barrier
    v_mfma_f32_16x16x32_bf16 v[48:51], v[192:195], v[176:179], v[48:51]
    ds_read_b128 v[112:115], v4 offset:32768
    ds_read_b64_tr_b16 v[128:129], v8 offset:49152
    v_mfma_f32_16x16x32_bf16 v[52:55], v[192:195], v[180:183], v[52:55]
    ds_read_b128 v[116:119], v4 offset:34816
    ds_read_b64_tr_b16 v[130:131], v8 offset:49664
    v_mfma_f32_16x16x32_bf16 v[64:67], v[192:195], v[184:187], v[64:67]
    ds_read_b128 v[120:123], v4 offset:36864
    ds_read_b64_tr_b16 v[132:133], v6 offset:49152
    v_mfma_f32_16x16x32_bf16 v[68:71], v[192:195], v[188:191], v[68:71]
    ds_read_b128 v[124:127], v4 offset:38912
    ds_read_b64_tr_b16 v[134:135], v6 offset:49664
    v_mfma_f32_16x16x32_bf16 v[56:59], v[196:199], v[176:179], v[56:59]
    ds_read_b128 v[144:147], v5 offset:32768
    ds_read_b64_tr_b16 v[160:161], v8 offset:53248
    v_mfma_f32_16x16x32_bf16 v[60:63], v[196:199], v[180:183], v[60:63]
    ds_read_b128 v[148:151], v5 offset:34816
    ds_read_b64_tr_b16 v[162:163], v8 offset:53760
    v_mfma_f32_16x16x32_bf16 v[72:75], v[196:199], v[184:187], v[72:75]
    ds_read_b128 v[152:155], v5 offset:36864
    ds_read_b64_tr_b16 v[164:165], v6 offset:53248
    v_mfma_f32_16x16x32_bf16 v[76:79], v[196:199], v[188:191], v[76:79]
    ds_read_b128 v[156:159], v5 offset:38912
    ds_read_b64_tr_b16 v[166:167], v6 offset:53760
    v_mfma_f32_16x16x32_bf16 v[48:51], v[224:227], v[208:211], v[48:51]
    v_mfma_f32_16x16x32_bf16 v[52:55], v[224:227], v[212:215], v[52:55]
    v_mfma_f32_16x16x32_bf16 v[64:67], v[224:227], v[216:219], v[64:67]
    v_mfma_f32_16x16x32_bf16 v[68:71], v[224:227], v[220:223], v[68:71]
    v_mfma_f32_16x16x32_bf16 v[56:59], v[228:231], v[208:211], v[56:59]
    v_mfma_f32_16x16x32_bf16 v[60:63], v[228:231], v[212:215], v[60:63]
    v_mfma_f32_16x16x32_bf16 v[72:75], v[228:231], v[216:219], v[72:75]
    v_mfma_f32_16x16x32_bf16 v[76:79], v[228:231], v[220:223], v[76:79]
    s_waitcnt lgkmcnt(0)
    s_barrier
    v_mfma_f32_16x16x32_bf16 v[48:51], v[128:131], v[112:115], v[48:51]
    ds_read_b128 v[176:179], v4 offset:49152
    ds_read_b64_tr_b16 v[192:193], v8 offset:57344
    v_mfma_f32_16x16x32_bf16 v[52:55], v[128:131], v[116:119], v[52:55]
    ds_read_b128 v[180:183], v4 offset:51200
    ds_read_b64_tr_b16 v[194:195], v8 offset:57856
    v_mfma_f32_16x16x32_bf16 v[64:67], v[128:131], v[120:123], v[64:67]
    ds_read_b128 v[184:187], v4 offset:53248
    ds_read_b64_tr_b16 v[196:197], v6 offset:57344
    v_mfma_f32_16x16x32_bf16 v[68:71], v[128:131], v[124:127], v[68:71]
    ds_read_b128 v[188:191], v4 offset:55296
    ds_read_b64_tr_b16 v[198:199], v6 offset:57856
    v_mfma_f32_16x16x32_bf16 v[56:59], v[132:135], v[112:115], v[56:59]
    ds_read_b128 v[208:211], v5 offset:49152
    ds_read_b64_tr_b16 v[224:225], v8 offset:61440
    v_mfma_f32_16x16x32_bf16 v[60:63], v[132:135], v[116:119], v[60:63]
    ds_read_b128 v[212:215], v5 offset:51200
    ds_read_b64_tr_b16 v[226:227], v8 offset:61952
    v_mfma_f32_16x16x32_bf16 v[72:75], v[132:135], v[120:123], v[72:75]
    ds_read_b128 v[216:219], v5 offset:53248
    ds_read_b64_tr_b16 v[228:229], v6 offset:61440
    v_mfma_f32_16x16x32_bf16 v[76:79], v[132:135], v[124:127], v[76:79]
    ds_read_b128 v[220:223], v5 offset:55296
    ds_read_b64_tr_b16 v[230:231], v6 offset:61952
    v_mfma_f32_16x16x32_bf16 v[48:51], v[160:163], v[144:147], v[48:51]
    v_mfma_f32_16x16x32_bf16 v[52:55], v[160:163], v[148:151], v[52:55]
    v_mfma_f32_16x16x32_bf16 v[64:67], v[160:163], v[152:155], v[64:67]
    v_mfma_f32_16x16x32_bf16 v[68:71], v[160:163], v[156:159], v[68:71]
    v_mfma_f32_16x16x32_bf16 v[56:59], v[164:167], v[144:147], v[56:59]
    v_mfma_f32_16x16x32_bf16 v[60:63], v[164:167], v[148:151], v[60:63]
    v_mfma_f32_16x16x32_bf16 v[72:75], v[164:167], v[152:155], v[72:75]
    v_mfma_f32_16x16x32_bf16 v[76:79], v[164:167], v[156:159], v[76:79]
    s_waitcnt lgkmcnt(0)
    s_barrier
    v_mfma_f32_16x16x32_bf16 v[48:51], v[192:195], v[176:179], v[48:51]
    v_xor_b32 v4, 0x10000, v4
    v_xor_b32 v5, 0x10000, v5
    v_mfma_f32_16x16x32_bf16 v[52:55], v[192:195], v[180:183], v[52:55]
    ds_read_b128 v[112:115], v4 offset:0
    ds_read_b64_tr_b16 v[128:129], v8 offset:32768
    v_mfma_f32_16x16x32_bf16 v[64:67], v[192:195], v[184:187], v[64:67]
    ds_read_b128 v[116:119], v4 offset:2048
    ds_read_b64_tr_b16 v[130:131], v8 offset:33280
    v_mfma_f32_16x16x32_bf16 v[68:71], v[192:195], v[188:191], v[68:71]
    ds_read_b128 v[120:123], v4 offset:4096
    ds_read_b64_tr_b16 v[132:133], v6 offset:32768
    v_mfma_f32_16x16x32_bf16 v[56:59], v[196:199], v[176:179], v[56:59]
    ds_read_b128 v[124:127], v4 offset:6144
    ds_read_b64_tr_b16 v[134:135], v6 offset:33280
    v_mfma_f32_16x16x32_bf16 v[60:63], v[196:199], v[180:183], v[60:63]
    ds_read_b128 v[144:147], v5 offset:0
    ds_read_b64_tr_b16 v[160:161], v8 offset:36864
    v_mfma_f32_16x16x32_bf16 v[72:75], v[196:199], v[184:187], v[72:75]
    ds_read_b128 v[148:151], v5 offset:2048
    ds_read_b64_tr_b16 v[162:163], v8 offset:37376
    v_mfma_f32_16x16x32_bf16 v[76:79], v[196:199], v[188:191], v[76:79]
    ds_read_b128 v[152:155], v5 offset:4096
    ds_read_b64_tr_b16 v[164:165], v6 offset:36864
    v_mfma_f32_16x16x32_bf16 v[48:51], v[224:227], v[208:211], v[48:51]
    ds_read_b128 v[156:159], v5 offset:6144
    ds_read_b64_tr_b16 v[166:167], v6 offset:37376
    v_mfma_f32_16x16x32_bf16 v[52:55], v[224:227], v[212:215], v[52:55]
    v_mfma_f32_16x16x32_bf16 v[64:67], v[224:227], v[216:219], v[64:67]
    v_mfma_f32_16x16x32_bf16 v[68:71], v[224:227], v[220:223], v[68:71]
    v_mfma_f32_16x16x32_bf16 v[56:59], v[228:231], v[208:211], v[56:59]
    v_mfma_f32_16x16x32_bf16 v[60:63], v[228:231], v[212:215], v[60:63]
    v_mfma_f32_16x16x32_bf16 v[72:75], v[228:231], v[216:219], v[72:75]
    v_mfma_f32_16x16x32_bf16 v[76:79], v[228:231], v[220:223], v[76:79]
    s_waitcnt lgkmcnt(0)
    s_barrier
    v_mfma_f32_16x16x32_bf16 v[48:51], v[128:131], v[112:115], v[48:51]
    ds_read_b128 v[176:179], v4 offset:16384
    ds_read_b64_tr_b16 v[192:193], v8 offset:40960
    v_mfma_f32_16x16x32_bf16 v[52:55], v[128:131], v[116:119], v[52:55]
    ds_read_b128 v[180:183], v4 offset:18432
    ds_read_b64_tr_b16 v[194:195], v8 offset:41472
    v_mfma_f32_16x16x32_bf16 v[64:67], v[128:131], v[120:123], v[64:67]
    ds_read_b128 v[184:187], v4 offset:20480
    ds_read_b64_tr_b16 v[196:197], v6 offset:40960
    v_mfma_f32_16x16x32_bf16 v[68:71], v[128:131], v[124:127], v[68:71]
    ds_read_b128 v[188:191], v4 offset:22528
    ds_read_b64_tr_b16 v[198:199], v6 offset:41472
    v_mfma_f32_16x16x32_bf16 v[56:59], v[132:135], v[112:115], v[56:59]
    ds_read_b128 v[208:211], v5 offset:16384
    ds_read_b64_tr_b16 v[224:225], v8 offset:45056
    v_mfma_f32_16x16x32_bf16 v[60:63], v[132:135], v[116:119], v[60:63]
    ds_read_b128 v[212:215], v5 offset:18432
    ds_read_b64_tr_b16 v[226:227], v8 offset:45568
    v_mfma_f32_16x16x32_bf16 v[72:75], v[132:135], v[120:123], v[72:75]
    ds_read_b128 v[216:219], v5 offset:20480
    ds_read_b64_tr_b16 v[228:229], v6 offset:45056
    v_mfma_f32_16x16x32_bf16 v[76:79], v[132:135], v[124:127], v[76:79]
    ds_read_b128 v[220:223], v5 offset:22528
    ds_read_b64_tr_b16 v[230:231], v6 offset:45568
    v_mfma_f32_16x16x32_bf16 v[48:51], v[160:163], v[144:147], v[48:51]
    v_mfma_f32_16x16x32_bf16 v[52:55], v[160:163], v[148:151], v[52:55]
    v_mfma_f32_16x16x32_bf16 v[64:67], v[160:163], v[152:155], v[64:67]
    v_mfma_f32_16x16x32_bf16 v[68:71], v[160:163], v[156:159], v[68:71]
    v_mfma_f32_16x16x32_bf16 v[56:59], v[164:167], v[144:147], v[56:59]
    v_mfma_f32_16x16x32_bf16 v[60:63], v[164:167], v[148:151], v[60:63]
    v_mfma_f32_16x16x32_bf16 v[72:75], v[164:167], v[152:155], v[72:75]
    v_mfma_f32_16x16x32_bf16 v[76:79], v[164:167], v[156:159], v[76:79]
    s_waitcnt lgkmcnt(0)
    s_barrier
    v_mfma_f32_16x16x32_bf16 v[48:51], v[192:195], v[176:179], v[48:51]
    ds_read_b128 v[112:115], v4 offset:32768
    ds_read_b64_tr_b16 v[128:129], v8 offset:49152
    v_mfma_f32_16x16x32_bf16 v[52:55], v[192:195], v[180:183], v[52:55]
    ds_read_b128 v[116:119], v4 offset:34816
    ds_read_b64_tr_b16 v[130:131], v8 offset:49664
    v_mfma_f32_16x16x32_bf16 v[64:67], v[192:195], v[184:187], v[64:67]
    ds_read_b128 v[120:123], v4 offset:36864
    ds_read_b64_tr_b16 v[132:133], v6 offset:49152
    v_mfma_f32_16x16x32_bf16 v[68:71], v[192:195], v[188:191], v[68:71]
    ds_read_b128 v[124:127], v4 offset:38912
    ds_read_b64_tr_b16 v[134:135], v6 offset:49664
    v_mfma_f32_16x16x32_bf16 v[56:59], v[196:199], v[176:179], v[56:59]
    ds_read_b128 v[144:147], v5 offset:32768
    ds_read_b64_tr_b16 v[160:161], v8 offset:53248
    v_mfma_f32_16x16x32_bf16 v[60:63], v[196:199], v[180:183], v[60:63]
    ds_read_b128 v[148:151], v5 offset:34816
    ds_read_b64_tr_b16 v[162:163], v8 offset:53760
    v_mfma_f32_16x16x32_bf16 v[72:75], v[196:199], v[184:187], v[72:75]
    ds_read_b128 v[152:155], v5 offset:36864
    ds_read_b64_tr_b16 v[164:165], v6 offset:53248
    v_mfma_f32_16x16x32_bf16 v[76:79], v[196:199], v[188:191], v[76:79]
    ds_read_b128 v[156:159], v5 offset:38912
    ds_read_b64_tr_b16 v[166:167], v6 offset:53760
    v_mfma_f32_16x16x32_bf16 v[48:51], v[224:227], v[208:211], v[48:51]
    v_mfma_f32_16x16x32_bf16 v[52:55], v[224:227], v[212:215], v[52:55]
    v_mfma_f32_16x16x32_bf16 v[64:67], v[224:227], v[216:219], v[64:67]
    v_mfma_f32_16x16x32_bf16 v[68:71], v[224:227], v[220:223], v[68:71]
    v_mfma_f32_16x16x32_bf16 v[56:59], v[228:231], v[208:211], v[56:59]
    v_mfma_f32_16x16x32_bf16 v[60:63], v[228:231], v[212:215], v[60:63]
    v_mfma_f32_16x16x32_bf16 v[72:75], v[228:231], v[216:219], v[72:75]
    v_mfma_f32_16x16x32_bf16 v[76:79], v[228:231], v[220:223], v[76:79]
    s_waitcnt lgkmcnt(0)
    s_barrier
    v_mfma_f32_16x16x32_bf16 v[48:51], v[128:131], v[112:115], v[48:51]
    ds_read_b128 v[176:179], v4 offset:49152
    ds_read_b64_tr_b16 v[192:193], v8 offset:57344
    v_mfma_f32_16x16x32_bf16 v[52:55], v[128:131], v[116:119], v[52:55]
    ds_read_b128 v[180:183], v4 offset:51200
    ds_read_b64_tr_b16 v[194:195], v8 offset:57856
    v_mfma_f32_16x16x32_bf16 v[64:67], v[128:131], v[120:123], v[64:67]
    ds_read_b128 v[184:187], v4 offset:53248
    ds_read_b64_tr_b16 v[196:197], v6 offset:57344
    v_mfma_f32_16x16x32_bf16 v[68:71], v[128:131], v[124:127], v[68:71]
    ds_read_b128 v[188:191], v4 offset:55296
    ds_read_b64_tr_b16 v[198:199], v6 offset:57856
    v_mfma_f32_16x16x32_bf16 v[56:59], v[132:135], v[112:115], v[56:59]
    ds_read_b128 v[208:211], v5 offset:49152
    ds_read_b64_tr_b16 v[224:225], v8 offset:61440
    v_mfma_f32_16x16x32_bf16 v[60:63], v[132:135], v[116:119], v[60:63]
    ds_read_b128 v[212:215], v5 offset:51200
    ds_read_b64_tr_b16 v[226:227], v8 offset:61952
    v_mfma_f32_16x16x32_bf16 v[72:75], v[132:135], v[120:123], v[72:75]
    ds_read_b128 v[216:219], v5 offset:53248
    ds_read_b64_tr_b16 v[228:229], v6 offset:61440
    v_mfma_f32_16x16x32_bf16 v[76:79], v[132:135], v[124:127], v[76:79]
    ds_read_b128 v[220:223], v5 offset:55296
    ds_read_b64_tr_b16 v[230:231], v6 offset:61952
    v_mfma_f32_16x16x32_bf16 v[48:51], v[160:163], v[144:147], v[48:51]
    v_mfma_f32_16x16x32_bf16 v[52:55], v[160:163], v[148:151], v[52:55]
    v_mfma_f32_16x16x32_bf16 v[64:67], v[160:163], v[152:155], v[64:67]
    v_mfma_f32_16x16x32_bf16 v[68:71], v[160:163], v[156:159], v[68:71]
    v_mfma_f32_16x16x32_bf16 v[56:59], v[164:167], v[144:147], v[56:59]
    v_mfma_f32_16x16x32_bf16 v[60:63], v[164:167], v[148:151], v[60:63]
    v_mfma_f32_16x16x32_bf16 v[72:75], v[164:167], v[152:155], v[72:75]
    v_mfma_f32_16x16x32_bf16 v[76:79], v[164:167], v[156:159], v[76:79]
    s_waitcnt lgkmcnt(0)
    s_barrier
    v_mfma_f32_16x16x32_bf16 v[48:51], v[192:195], v[176:179], v[48:51]
    v_xor_b32 v4, 0x10000, v4
    v_mfma_f32_16x16x32_bf16 v[52:55], v[192:195], v[180:183], v[52:55]
    v_xor_b32 v5, 0x10000, v5
    v_mfma_f32_16x16x32_bf16 v[64:67], v[192:195], v[184:187], v[64:67]
    s_xor_b32 s53, s69, 256
    v_mfma_f32_16x16x32_bf16 v[68:71], v[192:195], v[188:191], v[68:71]
    s_lshl_b32 s53, s53, 10
    v_mfma_f32_16x16x32_bf16 v[56:59], v[196:199], v[176:179], v[56:59]
    s_add_u32 s53, s53, 0
    v_mfma_f32_16x16x32_bf16 v[60:63], v[196:199], v[180:183], v[60:63]
    s_add_u32 s54, s53, 65536
    v_mfma_f32_16x16x32_bf16 v[72:75], v[196:199], v[184:187], v[72:75]
    s_xor_b32 s57, s69, 512
    v_mfma_f32_16x16x32_bf16 v[76:79], v[196:199], v[188:191], v[76:79]
    s_lshl_b32 s57, s57, 11
    v_mfma_f32_16x16x32_bf16 v[48:51], v[224:227], v[208:211], v[48:51]
    s_add_u32 s57, s57, 2097152
    v_mfma_f32_16x16x32_bf16 v[52:55], v[224:227], v[212:215], v[52:55]
    v_mfma_f32_16x16x32_bf16 v[64:67], v[224:227], v[216:219], v[64:67]
    v_mfma_f32_16x16x32_bf16 v[68:71], v[224:227], v[220:223], v[68:71]
    v_mfma_f32_16x16x32_bf16 v[56:59], v[228:231], v[208:211], v[56:59]
    v_mfma_f32_16x16x32_bf16 v[60:63], v[228:231], v[212:215], v[60:63]
    v_mfma_f32_16x16x32_bf16 v[72:75], v[228:231], v[216:219], v[72:75]
    v_mfma_f32_16x16x32_bf16 v[76:79], v[228:231], v[220:223], v[76:79]
    s_nop 11
    s_add_u32 s58, s57, 131072
    v_pk_mul_f32 v[48:49], v[48:49], s[60:61] op_sel:[0,1] op_sel_hi:[1,1]
    v_pk_mul_f32 v[50:51], v[50:51], s[60:61] op_sel:[0,1] op_sel_hi:[1,1]
    v_pk_mul_f32 v[52:53], v[52:53], s[60:61] op_sel:[0,1] op_sel_hi:[1,1]
    v_pk_mul_f32 v[54:55], v[54:55], s[60:61] op_sel:[0,1] op_sel_hi:[1,1]
    v_pk_mul_f32 v[56:57], v[56:57], s[60:61] op_sel:[0,1] op_sel_hi:[1,1]
    v_pk_mul_f32 v[58:59], v[58:59], s[60:61] op_sel:[0,1] op_sel_hi:[1,1]
    v_pk_mul_f32 v[60:61], v[60:61], s[60:61] op_sel:[0,1] op_sel_hi:[1,1]
    v_pk_mul_f32 v[62:63], v[62:63], s[60:61] op_sel:[0,1] op_sel_hi:[1,1]
    v_cvt_pk_bf16_f32 v16, v48, v49
    v_cvt_pk_bf16_f32 v17, v50, v51
    v_cvt_pk_bf16_f32 v18, v52, v53
    v_cvt_pk_bf16_f32 v19, v54, v55
    v_cvt_pk_bf16_f32 v20, v56, v57
    v_cvt_pk_bf16_f32 v21, v58, v59
    v_cvt_pk_bf16_f32 v22, v60, v61
    v_cvt_pk_bf16_f32 v23, v62, v63
    v_permlane16_swap_b32 v16, v18
    v_permlane16_swap_b32 v17, v19
    v_permlane16_swap_b32 v20, v22
    v_permlane16_swap_b32 v21, v23
    buffer_store_dwordx4 v[16:19], v1, s[40:43], s53 offen offset:0 sc1
    buffer_store_dwordx4 v[20:23], v1, s[40:43], s54 offen offset:0 sc1
    v_pk_mul_f32 v[64:65], v[64:65], s[60:61] op_sel:[0,1] op_sel_hi:[1,1]
    v_pk_mul_f32 v[66:67], v[66:67], s[60:61] op_sel:[0,1] op_sel_hi:[1,1]
    v_pk_mul_f32 v[68:69], v[68:69], s[60:61] op_sel:[0,1] op_sel_hi:[1,1]
    v_pk_mul_f32 v[70:71], v[70:71], s[60:61] op_sel:[0,1] op_sel_hi:[1,1]
    v_pk_mul_f32 v[72:73], v[72:73], s[60:61] op_sel:[0,1] op_sel_hi:[1,1]
    v_pk_mul_f32 v[74:75], v[74:75], s[60:61] op_sel:[0,1] op_sel_hi:[1,1]
    v_pk_mul_f32 v[76:77], v[76:77], s[60:61] op_sel:[0,1] op_sel_hi:[1,1]
    v_pk_mul_f32 v[78:79], v[78:79], s[60:61] op_sel:[0,1] op_sel_hi:[1,1]
    v_cvt_pk_bf16_f32 v24, v64, v65
    v_cvt_pk_bf16_f32 v25, v66, v67
    v_cvt_pk_bf16_f32 v26, v68, v69
    v_cvt_pk_bf16_f32 v27, v70, v71
    v_cvt_pk_bf16_f32 v28, v72, v73
    v_cvt_pk_bf16_f32 v29, v74, v75
    v_cvt_pk_bf16_f32 v30, v76, v77
    v_cvt_pk_bf16_f32 v31, v78, v79
    v_permlane16_swap_b32 v24, v26
    v_permlane16_swap_b32 v25, v27
    v_permlane16_swap_b32 v28, v30
    v_permlane16_swap_b32 v29, v31
    buffer_store_dwordx4 v[24:27], v1, s[40:43], s53 offen offset:1024 sc1
    buffer_store_dwordx4 v[28:31], v1, s[40:43], s54 offen offset:1024 sc1
    global_load_dword v10, v3, s[22:23] sc1
.p2align 3
    s_barrier
    s_nop 0
    ds_read_b128 v[112:115], v4 offset:0
    ds_read_b64_tr_b16 v[128:129], v8 offset:32768
    ds_read_b64_tr_b16 v[130:131], v8 offset:33280
    ds_read_b128 v[116:119], v4 offset:2048
    ds_read_b64_tr_b16 v[132:133], v6 offset:32768
    ds_read_b64_tr_b16 v[134:135], v6 offset:33280
    ds_read_b128 v[120:123], v4 offset:4096
    ds_read_b64_tr_b16 v[136:137], v8 offset:40960
    ds_read_b64_tr_b16 v[138:139], v8 offset:41472
    ds_read_b128 v[124:127], v4 offset:6144
    ds_read_b64_tr_b16 v[140:141], v6 offset:40960
    ds_read_b64_tr_b16 v[142:143], v6 offset:41472
    ds_read_b128 v[144:147], v5 offset:0
    ds_read_b64_tr_b16 v[160:161], v8 offset:36864
    ds_read_b64_tr_b16 v[162:163], v8 offset:37376
    ds_read_b128 v[148:151], v5 offset:2048
    ds_read_b64_tr_b16 v[164:165], v6 offset:36864
    ds_read_b64_tr_b16 v[166:167], v6 offset:37376
    ds_read_b128 v[152:155], v5 offset:4096
    ds_read_b64_tr_b16 v[168:169], v8 offset:45056
    ds_read_b64_tr_b16 v[170:171], v8 offset:45568
    ds_read_b128 v[156:159], v5 offset:6144
    ds_read_b64_tr_b16 v[172:173], v6 offset:45056
    ds_read_b64_tr_b16 v[174:175], v6 offset:45568
    s_waitcnt lgkmcnt(0)
    s_barrier
    v_mfma_f32_16x16x32_bf16 v[48:51], v[128:131], v[112:115], 0
    ds_read_b128 v[176:179], v4 offset:16384
    v_mfma_f32_16x16x32_bf16 v[52:55], v[128:131], v[116:119], 0
    ds_read_b64_tr_b16 v[192:193], v8 offset:49152
    v_mfma_f32_16x16x32_bf16 v[64:67], v[128:131], v[120:123], 0
    ds_read_b64_tr_b16 v[194:195], v8 offset:49664
    v_mfma_f32_16x16x32_bf16 v[68:71], v[128:131], v[124:127], 0
    ds_read_b128 v[180:183], v4 offset:18432
    v_mfma_f32_16x16x32_bf16 v[56:59], v[132:135], v[112:115], 0
    ds_read_b64_tr_b16 v[196:197], v6 offset:49152
    v_mfma_f32_16x16x32_bf16 v[60:63], v[132:135], v[116:119], 0
    ds_read_b64_tr_b16 v[198:199], v6 offset:49664
    v_mfma_f32_16x16x32_bf16 v[72:75], v[132:135], v[120:123], 0
    ds_read_b128 v[184:187], v4 offset:20480
    v_mfma_f32_16x16x32_bf16 v[76:79], v[132:135], v[124:127], 0
    ds_read_b64_tr_b16 v[200:201], v8 offset:57344
    v_mfma_f32_16x16x32_bf16 v[80:83], v[112:115], v[136:139], 0
    ds_read_b64_tr_b16 v[202:203], v8 offset:57856
    v_mfma_f32_16x16x32_bf16 v[84:87], v[116:119], v[136:139], 0
    ds_read_b128 v[188:191], v4 offset:22528
    v_mfma_f32_16x16x32_bf16 v[96:99], v[120:123], v[136:139], 0
    ds_read_b64_tr_b16 v[204:205], v6 offset:57344
    v_mfma_f32_16x16x32_bf16 v[100:103], v[124:127], v[136:139], 0
    ds_read_b64_tr_b16 v[206:207], v6 offset:57856
    v_mfma_f32_16x16x32_bf16 v[88:91], v[112:115], v[140:143], 0
    ds_read_b128 v[208:211], v5 offset:16384
    v_mfma_f32_16x16x32_bf16 v[92:95], v[116:119], v[140:143], 0
    ds_read_b64_tr_b16 v[224:225], v8 offset:53248
    v_mfma_f32_16x16x32_bf16 v[104:107], v[120:123], v[140:143], 0
    ds_read_b64_tr_b16 v[226:227], v8 offset:53760
    v_mfma_f32_16x16x32_bf16 v[108:111], v[124:127], v[140:143], 0
    ds_read_b128 v[212:215], v5 offset:18432
    v_mfma_f32_16x16x32_bf16 v[48:51], v[160:163], v[144:147], v[48:51]
    ds_read_b64_tr_b16 v[228:229], v6 offset:53248
    v_mfma_f32_16x16x32_bf16 v[52:55], v[160:163], v[148:151], v[52:55]
    ds_read_b64_tr_b16 v[230:231], v6 offset:53760
    v_mfma_f32_16x16x32_bf16 v[64:67], v[160:163], v[152:155], v[64:67]
    ds_read_b128 v[216:219], v5 offset:20480
    v_mfma_f32_16x16x32_bf16 v[68:71], v[160:163], v[156:159], v[68:71]
    ds_read_b64_tr_b16 v[232:233], v8 offset:61440
    v_mfma_f32_16x16x32_bf16 v[56:59], v[164:167], v[144:147], v[56:59]
    ds_read_b64_tr_b16 v[234:235], v8 offset:61952
    v_mfma_f32_16x16x32_bf16 v[60:63], v[164:167], v[148:151], v[60:63]
    ds_read_b128 v[220:223], v5 offset:22528
    v_mfma_f32_16x16x32_bf16 v[72:75], v[164:167], v[152:155], v[72:75]
    ds_read_b64_tr_b16 v[236:237], v6 offset:61440
    v_mfma_f32_16x16x32_bf16 v[76:79], v[164:167], v[156:159], v[76:79]
    ds_read_b64_tr_b16 v[238:239], v6 offset:61952
    v_mfma_f32_16x16x32_bf16 v[80:83], v[144:147], v[168:171], v[80:83]
    v_mfma_f32_16x16x32_bf16 v[84:87], v[148:151], v[168:171], v[84:87]
    v_mfma_f32_16x16x32_bf16 v[96:99], v[152:155], v[168:171], v[96:99]
    v_mfma_f32_16x16x32_bf16 v[100:103], v[156:159], v[168:171], v[100:103]
    v_mfma_f32_16x16x32_bf16 v[88:91], v[144:147], v[172:175], v[88:91]
    v_mfma_f32_16x16x32_bf16 v[92:95], v[148:151], v[172:175], v[92:95]
    v_mfma_f32_16x16x32_bf16 v[104:107], v[152:155], v[172:175], v[104:107]
    v_mfma_f32_16x16x32_bf16 v[108:111], v[156:159], v[172:175], v[108:111]
    s_waitcnt lgkmcnt(0) vmcnt(0)
    s_barrier
    s_cmp_lg_u32 s48, 0
    s_cbranch_scc1 L_drained1
    v_readfirstlane_b32 s58, v10
    s_mov_b32 s52, 20056064
    s_cmp_eq_u32 s58, 0
    s_cbranch_scc1 L_sig1
L_initok1:
    s_mov_b64 exec, 2
    buffer_atomic_add v15, v14, s[40:43], s52 offen sc1
    s_mov_b64 exec, -1
    s_nop 0
L_drained1:
    v_mfma_f32_16x16x32_bf16 v[48:51], v[192:195], v[176:179], v[48:51]
    ds_read_b128 v[112:115], v4 offset:32768
    v_mfma_f32_16x16x32_bf16 v[52:55], v[192:195], v[180:183], v[52:55]
    ds_read_b64_tr_b16 v[128:129], v8 offset:32768
    v_mfma_f32_16x16x32_bf16 v[64:67], v[192:195], v[184:187], v[64:67]
    ds_read_b64_tr_b16 v[130:131], v8 offset:33280
    v_mfma_f32_16x16x32_bf16 v[68:71], v[192:195], v[188:191], v[68:71]
    ds_read_b128 v[116:119], v4 offset:34816
    v_mfma_f32_16x16x32_bf16 v[56:59], v[196:199], v[176:179], v[56:59]
    ds_read_b64_tr_b16 v[132:133], v6 offset:32768
    v_mfma_f32_16x16x32_bf16 v[60:63], v[196:199], v[180:183], v[60:63]
    ds_read_b64_tr_b16 v[134:135], v6 offset:33280
    v_mfma_f32_16x16x32_bf16 v[72:75], v[196:199], v[184:187], v[72:75]
    ds_read_b128 v[120:123], v4 offset:36864
    v_mfma_f32_16x16x32_bf16 v[76:79], v[196:199], v[188:191], v[76:79]
    ds_read_b64_tr_b16 v[136:137], v8 offset:40960
    v_mfma_f32_16x16x32_bf16 v[80:83], v[176:179], v[200:203], v[80:83]
    ds_read_b64_tr_b16 v[138:139], v8 offset:41472
    v_mfma_f32_16x16x32_bf16 v[84:87], v[180:183], v[200:203], v[84:87]
    ds_read_b128 v[124:127], v4 offset:38912
    v_mfma_f32_16x16x32_bf16 v[96:99], v[184:187], v[200:203], v[96:99]
    ds_read_b64_tr_b16 v[140:141], v6 offset:40960
    v_mfma_f32_16x16x32_bf16 v[100:103], v[188:191], v[200:203], v[100:103]
    ds_read_b64_tr_b16 v[142:143], v6 offset:41472
    v_mfma_f32_16x16x32_bf16 v[88:91], v[176:179], v[204:207], v[88:91]
    ds_read_b128 v[144:147], v5 offset:32768
    v_mfma_f32_16x16x32_bf16 v[92:95], v[180:183], v[204:207], v[92:95]
    ds_read_b64_tr_b16 v[160:161], v8 offset:36864
    v_mfma_f32_16x16x32_bf16 v[104:107], v[184:187], v[204:207], v[104:107]
    ds_read_b64_tr_b16 v[162:163], v8 offset:37376
    v_mfma_f32_16x16x32_bf16 v[108:111], v[188:191], v[204:207], v[108:111]
    ds_read_b128 v[148:151], v5 offset:34816
    v_mfma_f32_16x16x32_bf16 v[48:51], v[224:227], v[208:211], v[48:51]
    ds_read_b64_tr_b16 v[164:165], v6 offset:36864
    v_mfma_f32_16x16x32_bf16 v[52:55], v[224:227], v[212:215], v[52:55]
    ds_read_b64_tr_b16 v[166:167], v6 offset:37376
    v_mfma_f32_16x16x32_bf16 v[64:67], v[224:227], v[216:219], v[64:67]
    ds_read_b128 v[152:155], v5 offset:36864
    v_mfma_f32_16x16x32_bf16 v[68:71], v[224:227], v[220:223], v[68:71]
    ds_read_b64_tr_b16 v[168:169], v8 offset:45056
    v_mfma_f32_16x16x32_bf16 v[56:59], v[228:231], v[208:211], v[56:59]
    ds_read_b64_tr_b16 v[170:171], v8 offset:45568
    v_mfma_f32_16x16x32_bf16 v[60:63], v[228:231], v[212:215], v[60:63]
    ds_read_b128 v[156:159], v5 offset:38912
    v_mfma_f32_16x16x32_bf16 v[72:75], v[228:231], v[216:219], v[72:75]
    ds_read_b64_tr_b16 v[172:173], v6 offset:45056
    v_mfma_f32_16x16x32_bf16 v[76:79], v[228:231], v[220:223], v[76:79]
    ds_read_b64_tr_b16 v[174:175], v6 offset:45568
    v_mfma_f32_16x16x32_bf16 v[80:83], v[208:211], v[232:235], v[80:83]
    v_mfma_f32_16x16x32_bf16 v[84:87], v[212:215], v[232:235], v[84:87]
    v_mfma_f32_16x16x32_bf16 v[96:99], v[216:219], v[232:235], v[96:99]
    v_mfma_f32_16x16x32_bf16 v[100:103], v[220:223], v[232:235], v[100:103]
    v_mfma_f32_16x16x32_bf16 v[88:91], v[208:211], v[236:239], v[88:91]
    v_mfma_f32_16x16x32_bf16 v[92:95], v[212:215], v[236:239], v[92:95]
    v_mfma_f32_16x16x32_bf16 v[104:107], v[216:219], v[236:239], v[104:107]
    v_mfma_f32_16x16x32_bf16 v[108:111], v[220:223], v[236:239], v[108:111]
    s_waitcnt lgkmcnt(0)
    s_barrier
    s_mov_b32 m0, s32
    s_nop 0
    buffer_load_dwordx4 v1, s[44:47], s36 offen lds
    v_mfma_f32_16x16x32_bf16 v[48:51], v[128:131], v[112:115], v[48:51]
    ds_read_b128 v[176:179], v4 offset:49152
    v_mfma_f32_16x16x32_bf16 v[52:55], v[128:131], v[116:119], v[52:55]
    ds_read_b64_tr_b16 v[192:193], v9 offset:0
    v_mfma_f32_16x16x32_bf16 v[64:67], v[128:131], v[120:123], v[64:67]
    ds_read_b64_tr_b16 v[194:195], v9 offset:512
    v_mfma_f32_16x16x32_bf16 v[68:71], v[128:131], v[124:127], v[68:71]
    ds_read_b128 v[180:183], v4 offset:51200
    v_mfma_f32_16x16x32_bf16 v[56:59], v[132:135], v[112:115], v[56:59]
    ds_read_b64_tr_b16 v[196:197], v7 offset:0
    v_mfma_f32_16x16x32_bf16 v[60:63], v[132:135], v[116:119], v[60:63]
    ds_read_b64_tr_b16 v[198:199], v7 offset:512
    v_mfma_f32_16x16x32_bf16 v[72:75], v[132:135], v[120:123], v[72:75]
    ds_read_b128 v[184:187], v4 offset:53248
    v_mfma_f32_16x16x32_bf16 v[76:79], v[132:135], v[124:127], v[76:79]
    ds_read_b64_tr_b16 v[200:201], v9 offset:8192
    v_mfma_f32_16x16x32_bf16 v[80:83], v[112:115], v[136:139], v[80:83]
    ds_read_b64_tr_b16 v[202:203], v9 offset:8704
    v_mfma_f32_16x16x32_bf16 v[84:87], v[116:119], v[136:139], v[84:87]
    ds_read_b128 v[188:191], v4 offset:55296
    v_mfma_f32_16x16x32_bf16 v[96:99], v[120:123], v[136:139], v[96:99]
    ds_read_b64_tr_b16 v[204:205], v7 offset:8192
    v_mfma_f32_16x16x32_bf16 v[100:103], v[124:127], v[136:139], v[100:103]
    ds_read_b64_tr_b16 v[206:207], v7 offset:8704
    v_mfma_f32_16x16x32_bf16 v[88:91], v[112:115], v[140:143], v[88:91]
    ds_read_b128 v[208:211], v5 offset:49152
    v_mfma_f32_16x16x32_bf16 v[92:95], v[116:119], v[140:143], v[92:95]
    ds_read_b64_tr_b16 v[224:225], v9 offset:4096
    v_mfma_f32_16x16x32_bf16 v[104:107], v[120:123], v[140:143], v[104:107]
    ds_read_b64_tr_b16 v[226:227], v9 offset:4608
    v_mfma_f32_16x16x32_bf16 v[108:111], v[124:127], v[140:143], v[108:111]
    ds_read_b128 v[212:215], v5 offset:51200
    v_mfma_f32_16x16x32_bf16 v[48:51], v[160:163], v[144:147], v[48:51]
    ds_read_b64_tr_b16 v[228:229], v7 offset:4096
    v_mfma_f32_16x16x32_bf16 v[52:55], v[160:163], v[148:151], v[52:55]
    ds_read_b64_tr_b16 v[230:231], v7 offset:4608
    v_mfma_f32_16x16x32_bf16 v[64:67], v[160:163], v[152:155], v[64:67]
    ds_read_b128 v[216:219], v5 offset:53248
    v_mfma_f32_16x16x32_bf16 v[68:71], v[160:163], v[156:159], v[68:71]
    ds_read_b64_tr_b16 v[232:233], v9 offset:12288
    v_mfma_f32_16x16x32_bf16 v[56:59], v[164:167], v[144:147], v[56:59]
    ds_read_b64_tr_b16 v[234:235], v9 offset:12800
    v_mfma_f32_16x16x32_bf16 v[60:63], v[164:167], v[148:151], v[60:63]
    ds_read_b128 v[220:223], v5 offset:55296
    v_mfma_f32_16x16x32_bf16 v[72:75], v[164:167], v[152:155], v[72:75]
    ds_read_b64_tr_b16 v[236:237], v7 offset:12288
    v_mfma_f32_16x16x32_bf16 v[76:79], v[164:167], v[156:159], v[76:79]
    ds_read_b64_tr_b16 v[238:239], v7 offset:12800
    v_mfma_f32_16x16x32_bf16 v[80:83], v[144:147], v[168:171], v[80:83]
    v_mfma_f32_16x16x32_bf16 v[84:87], v[148:151], v[168:171], v[84:87]
    v_mfma_f32_16x16x32_bf16 v[96:99], v[152:155], v[168:171], v[96:99]
    v_mfma_f32_16x16x32_bf16 v[100:103], v[156:159], v[168:171], v[100:103]
    v_mfma_f32_16x16x32_bf16 v[88:91], v[144:147], v[172:175], v[88:91]
    v_mfma_f32_16x16x32_bf16 v[92:95], v[148:151], v[172:175], v[92:95]
    v_mfma_f32_16x16x32_bf16 v[104:107], v[152:155], v[172:175], v[104:107]
    v_mfma_f32_16x16x32_bf16 v[108:111], v[156:159], v[172:175], v[108:111]
    s_waitcnt lgkmcnt(0)
    s_barrier
    v_mfma_f32_16x16x32_bf16 v[48:51], v[192:195], v[176:179], v[48:51]
    v_xor_b32 v4, 0x10000, v4
    v_xor_b32 v5, 0x10000, v5
    v_mfma_f32_16x16x32_bf16 v[52:55], v[192:195], v[180:183], v[52:55]
    ds_read_b128 v[112:115], v4 offset:0
    v_mfma_f32_16x16x32_bf16 v[64:67], v[192:195], v[184:187], v[64:67]
    ds_read_b64_tr_b16 v[128:129], v8 offset:49152
    v_mfma_f32_16x16x32_bf16 v[68:71], v[192:195], v[188:191], v[68:71]
    ds_read_b64_tr_b16 v[130:131], v8 offset:49664
    v_mfma_f32_16x16x32_bf16 v[56:59], v[196:199], v[176:179], v[56:59]
    ds_read_b128 v[116:119], v4 offset:2048
    v_mfma_f32_16x16x32_bf16 v[60:63], v[196:199], v[180:183], v[60:63]
    ds_read_b64_tr_b16 v[132:133], v6 offset:49152
    v_mfma_f32_16x16x32_bf16 v[72:75], v[196:199], v[184:187], v[72:75]
    ds_read_b64_tr_b16 v[134:135], v6 offset:49664
    v_mfma_f32_16x16x32_bf16 v[76:79], v[196:199], v[188:191], v[76:79]
    ds_read_b128 v[120:123], v4 offset:4096
    v_mfma_f32_16x16x32_bf16 v[80:83], v[176:179], v[200:203], v[80:83]
    ds_read_b64_tr_b16 v[136:137], v8 offset:57344
    v_mfma_f32_16x16x32_bf16 v[84:87], v[180:183], v[200:203], v[84:87]
    ds_read_b64_tr_b16 v[138:139], v8 offset:57856
    v_mfma_f32_16x16x32_bf16 v[96:99], v[184:187], v[200:203], v[96:99]
    ds_read_b128 v[124:127], v4 offset:6144
    v_mfma_f32_16x16x32_bf16 v[100:103], v[188:191], v[200:203], v[100:103]
    ds_read_b64_tr_b16 v[140:141], v6 offset:57344
    v_mfma_f32_16x16x32_bf16 v[88:91], v[176:179], v[204:207], v[88:91]
    ds_read_b64_tr_b16 v[142:143], v6 offset:57856
    v_mfma_f32_16x16x32_bf16 v[92:95], v[180:183], v[204:207], v[92:95]
    ds_read_b128 v[144:147], v5 offset:0
    v_mfma_f32_16x16x32_bf16 v[104:107], v[184:187], v[204:207], v[104:107]
    ds_read_b64_tr_b16 v[160:161], v8 offset:53248
    v_mfma_f32_16x16x32_bf16 v[108:111], v[188:191], v[204:207], v[108:111]
    ds_read_b64_tr_b16 v[162:163], v8 offset:53760
    v_mfma_f32_16x16x32_bf16 v[48:51], v[224:227], v[208:211], v[48:51]
    ds_read_b128 v[148:151], v5 offset:2048
    v_mfma_f32_16x16x32_bf16 v[52:55], v[224:227], v[212:215], v[52:55]
    ds_read_b64_tr_b16 v[164:165], v6 offset:53248
    v_mfma_f32_16x16x32_bf16 v[64:67], v[224:227], v[216:219], v[64:67]
    ds_read_b64_tr_b16 v[166:167], v6 offset:53760
    v_mfma_f32_16x16x32_bf16 v[68:71], v[224:227], v[220:223], v[68:71]
    ds_read_b128 v[152:155], v5 offset:4096
    v_mfma_f32_16x16x32_bf16 v[56:59], v[228:231], v[208:211], v[56:59]
    ds_read_b64_tr_b16 v[168:169], v8 offset:61440
    v_mfma_f32_16x16x32_bf16 v[60:63], v[228:231], v[212:215], v[60:63]
    ds_read_b64_tr_b16 v[170:171], v8 offset:61952
    v_mfma_f32_16x16x32_bf16 v[72:75], v[228:231], v[216:219], v[72:75]
    ds_read_b128 v[156:159], v5 offset:6144
    v_mfma_f32_16x16x32_bf16 v[76:79], v[228:231], v[220:223], v[76:79]
    ds_read_b64_tr_b16 v[172:173], v6 offset:61440
    v_mfma_f32_16x16x32_bf16 v[80:83], v[208:211], v[232:235], v[80:83]
    ds_read_b64_tr_b16 v[174:175], v6 offset:61952
    v_mfma_f32_16x16x32_bf16 v[84:87], v[212:215], v[232:235], v[84:87]
    v_mfma_f32_16x16x32_bf16 v[96:99], v[216:219], v[232:235], v[96:99]
    v_mfma_f32_16x16x32_bf16 v[100:103], v[220:223], v[232:235], v[100:103]
    v_mfma_f32_16x16x32_bf16 v[88:91], v[208:211], v[236:239], v[88:91]
    v_mfma_f32_16x16x32_bf16 v[92:95], v[212:215], v[236:239], v[92:95]
    v_mfma_f32_16x16x32_bf16 v[104:107], v[216:219], v[236:239], v[104:107]
    v_mfma_f32_16x16x32_bf16 v[108:111], v[220:223], v[236:239], v[108:111]
    s_waitcnt lgkmcnt(0)
    s_barrier
    v_mfma_f32_16x16x32_bf16 v[48:51], v[128:131], v[112:115], v[48:51]
    ds_read_b128 v[176:179], v4 offset:16384
    v_mfma_f32_16x16x32_bf16 v[52:55], v[128:131], v[116:119], v[52:55]
    ds_read_b64_tr_b16 v[192:193], v9 offset:16384
    v_mfma_f32_16x16x32_bf16 v[64:67], v[128:131], v[120:123], v[64:67]
    ds_read_b64_tr_b16 v[194:195], v9 offset:16896
    v_mfma_f32_16x16x32_bf16 v[68:71], v[128:131], v[124:127], v[68:71]
    ds_read_b128 v[180:183], v4 offset:18432
    v_mfma_f32_16x16x32_bf16 v[56:59], v[132:135], v[112:115], v[56:59]
    ds_read_b64_tr_b16 v[196:197], v7 offset:16384
    v_mfma_f32_16x16x32_bf16 v[60:63], v[132:135], v[116:119], v[60:63]
    ds_read_b64_tr_b16 v[198:199], v7 offset:16896
    v_mfma_f32_16x16x32_bf16 v[72:75], v[132:135], v[120:123], v[72:75]
    ds_read_b128 v[184:187], v4 offset:20480
    v_mfma_f32_16x16x32_bf16 v[76:79], v[132:135], v[124:127], v[76:79]
    ds_read_b64_tr_b16 v[200:201], v9 offset:24576
    v_mfma_f32_16x16x32_bf16 v[80:83], v[112:115], v[136:139], v[80:83]
    ds_read_b64_tr_b16 v[202:203], v9 offset:25088
    v_mfma_f32_16x16x32_bf16 v[84:87], v[116:119], v[136:139], v[84:87]
    ds_read_b128 v[188:191], v4 offset:22528
    v_mfma_f32_16x16x32_bf16 v[96:99], v[120:123], v[136:139], v[96:99]
    ds_read_b64_tr_b16 v[204:205], v7 offset:24576
    v_mfma_f32_16x16x32_bf16 v[100:103], v[124:127], v[136:139], v[100:103]
    ds_read_b64_tr_b16 v[206:207], v7 offset:25088
    v_mfma_f32_16x16x32_bf16 v[88:91], v[112:115], v[140:143], v[88:91]
    ds_read_b128 v[208:211], v5 offset:16384
    v_mfma_f32_16x16x32_bf16 v[92:95], v[116:119], v[140:143], v[92:95]
    ds_read_b64_tr_b16 v[224:225], v9 offset:20480
    v_mfma_f32_16x16x32_bf16 v[104:107], v[120:123], v[140:143], v[104:107]
    ds_read_b64_tr_b16 v[226:227], v9 offset:20992
    v_mfma_f32_16x16x32_bf16 v[108:111], v[124:127], v[140:143], v[108:111]
    ds_read_b128 v[212:215], v5 offset:18432
    v_mfma_f32_16x16x32_bf16 v[48:51], v[160:163], v[144:147], v[48:51]
    ds_read_b64_tr_b16 v[228:229], v7 offset:20480
    v_mfma_f32_16x16x32_bf16 v[52:55], v[160:163], v[148:151], v[52:55]
    ds_read_b64_tr_b16 v[230:231], v7 offset:20992
    v_mfma_f32_16x16x32_bf16 v[64:67], v[160:163], v[152:155], v[64:67]
    ds_read_b128 v[216:219], v5 offset:20480
    v_mfma_f32_16x16x32_bf16 v[68:71], v[160:163], v[156:159], v[68:71]
    ds_read_b64_tr_b16 v[232:233], v9 offset:28672
    v_mfma_f32_16x16x32_bf16 v[56:59], v[164:167], v[144:147], v[56:59]
    ds_read_b64_tr_b16 v[234:235], v9 offset:29184
    v_mfma_f32_16x16x32_bf16 v[60:63], v[164:167], v[148:151], v[60:63]
    ds_read_b128 v[220:223], v5 offset:22528
    v_mfma_f32_16x16x32_bf16 v[72:75], v[164:167], v[152:155], v[72:75]
    ds_read_b64_tr_b16 v[236:237], v7 offset:28672
    v_mfma_f32_16x16x32_bf16 v[76:79], v[164:167], v[156:159], v[76:79]
    ds_read_b64_tr_b16 v[238:239], v7 offset:29184
    v_mfma_f32_16x16x32_bf16 v[80:83], v[144:147], v[168:171], v[80:83]
    v_mfma_f32_16x16x32_bf16 v[84:87], v[148:151], v[168:171], v[84:87]
    v_mfma_f32_16x16x32_bf16 v[96:99], v[152:155], v[168:171], v[96:99]
    v_mfma_f32_16x16x32_bf16 v[100:103], v[156:159], v[168:171], v[100:103]
    v_mfma_f32_16x16x32_bf16 v[88:91], v[144:147], v[172:175], v[88:91]
    v_mfma_f32_16x16x32_bf16 v[92:95], v[148:151], v[172:175], v[92:95]
    v_mfma_f32_16x16x32_bf16 v[104:107], v[152:155], v[172:175], v[104:107]
    v_mfma_f32_16x16x32_bf16 v[108:111], v[156:159], v[172:175], v[108:111]
    s_waitcnt lgkmcnt(0)
    s_barrier
    v_mfma_f32_16x16x32_bf16 v[48:51], v[192:195], v[176:179], v[48:51]
    ds_read_b128 v[112:115], v4 offset:32768
    v_mfma_f32_16x16x32_bf16 v[52:55], v[192:195], v[180:183], v[52:55]
    ds_read_b64_tr_b16 v[128:129], v8 offset:32768
    v_mfma_f32_16x16x32_bf16 v[64:67], v[192:195], v[184:187], v[64:67]
    ds_read_b64_tr_b16 v[130:131], v8 offset:33280
    v_mfma_f32_16x16x32_bf16 v[68:71], v[192:195], v[188:191], v[68:71]
    ds_read_b128 v[116:119], v4 offset:34816
    v_mfma_f32_16x16x32_bf16 v[56:59], v[196:199], v[176:179], v[56:59]
    ds_read_b64_tr_b16 v[132:133], v6 offset:32768
    v_mfma_f32_16x16x32_bf16 v[60:63], v[196:199], v[180:183], v[60:63]
    ds_read_b64_tr_b16 v[134:135], v6 offset:33280
    v_mfma_f32_16x16x32_bf16 v[72:75], v[196:199], v[184:187], v[72:75]
    ds_read_b128 v[120:123], v4 offset:36864
    v_mfma_f32_16x16x32_bf16 v[76:79], v[196:199], v[188:191], v[76:79]
    ds_read_b64_tr_b16 v[136:137], v8 offset:40960
    v_mfma_f32_16x16x32_bf16 v[80:83], v[176:179], v[200:203], v[80:83]
    ds_read_b64_tr_b16 v[138:139], v8 offset:41472
    v_mfma_f32_16x16x32_bf16 v[84:87], v[180:183], v[200:203], v[84:87]
    ds_read_b128 v[124:127], v4 offset:38912
    v_mfma_f32_16x16x32_bf16 v[96:99], v[184:187], v[200:203], v[96:99]
    ds_read_b64_tr_b16 v[140:141], v6 offset:40960
    v_mfma_f32_16x16x32_bf16 v[100:103], v[188:191], v[200:203], v[100:103]
    ds_read_b64_tr_b16 v[142:143], v6 offset:41472
    v_mfma_f32_16x16x32_bf16 v[88:91], v[176:179], v[204:207], v[88:91]
    ds_read_b128 v[144:147], v5 offset:32768
    v_mfma_f32_16x16x32_bf16 v[92:95], v[180:183], v[204:207], v[92:95]
    ds_read_b64_tr_b16 v[160:161], v8 offset:36864
    v_mfma_f32_16x16x32_bf16 v[104:107], v[184:187], v[204:207], v[104:107]
    ds_read_b64_tr_b16 v[162:163], v8 offset:37376
    v_mfma_f32_16x16x32_bf16 v[108:111], v[188:191], v[204:207], v[108:111]
    ds_read_b128 v[148:151], v5 offset:34816
    v_mfma_f32_16x16x32_bf16 v[48:51], v[224:227], v[208:211], v[48:51]
    ds_read_b64_tr_b16 v[164:165], v6 offset:36864
    v_mfma_f32_16x16x32_bf16 v[52:55], v[224:227], v[212:215], v[52:55]
    ds_read_b64_tr_b16 v[166:167], v6 offset:37376
    v_mfma_f32_16x16x32_bf16 v[64:67], v[224:227], v[216:219], v[64:67]
    ds_read_b128 v[152:155], v5 offset:36864
    v_mfma_f32_16x16x32_bf16 v[68:71], v[224:227], v[220:223], v[68:71]
    ds_read_b64_tr_b16 v[168:169], v8 offset:45056
    v_mfma_f32_16x16x32_bf16 v[56:59], v[228:231], v[208:211], v[56:59]
    ds_read_b64_tr_b16 v[170:171], v8 offset:45568
    v_mfma_f32_16x16x32_bf16 v[60:63], v[228:231], v[212:215], v[60:63]
    ds_read_b128 v[156:159], v5 offset:38912
    v_mfma_f32_16x16x32_bf16 v[72:75], v[228:231], v[216:219], v[72:75]
    ds_read_b64_tr_b16 v[172:173], v6 offset:45056
    v_mfma_f32_16x16x32_bf16 v[76:79], v[228:231], v[220:223], v[76:79]
    ds_read_b64_tr_b16 v[174:175], v6 offset:45568
    v_mfma_f32_16x16x32_bf16 v[80:83], v[208:211], v[232:235], v[80:83]
    s_waitcnt vmcnt(0)
    v_mfma_f32_16x16x32_bf16 v[84:87], v[212:215], v[232:235], v[84:87]
    s_nop 0
    v_mfma_f32_16x16x32_bf16 v[96:99], v[216:219], v[232:235], v[96:99]
    ds_read_b64_tr_b16 v[248:249], v12 offset:0
    v_mfma_f32_16x16x32_bf16 v[100:103], v[220:223], v[232:235], v[100:103]
    ds_read_b64_tr_b16 v[250:251], v12 offset:128
    v_mfma_f32_16x16x32_bf16 v[88:91], v[208:211], v[236:239], v[88:91]
    ds_read_b64_tr_b16 v[252:253], v12 offset:512
    v_mfma_f32_16x16x32_bf16 v[92:95], v[212:215], v[236:239], v[92:95]
    ds_read_b64_tr_b16 v[254:255], v12 offset:640
    v_mfma_f32_16x16x32_bf16 v[104:107], v[216:219], v[236:239], v[104:107]
    v_mfma_f32_16x16x32_bf16 v[108:111], v[220:223], v[236:239], v[108:111]
    s_waitcnt lgkmcnt(0)
    s_barrier
    v_mfma_f32_16x16x32_bf16 v[48:51], v[128:131], v[112:115], v[48:51]
    ds_read_b128 v[176:179], v4 offset:49152
    v_mfma_f32_16x16x32_bf16 v[52:55], v[128:131], v[116:119], v[52:55]
    ds_read_b64_tr_b16 v[192:193], v8 offset:49152
    v_mfma_f32_16x16x32_bf16 v[64:67], v[128:131], v[120:123], v[64:67]
    ds_read_b64_tr_b16 v[194:195], v8 offset:49664
    v_mfma_f32_16x16x32_bf16 v[68:71], v[128:131], v[124:127], v[68:71]
    ds_read_b128 v[180:183], v4 offset:51200
    v_mfma_f32_16x16x32_bf16 v[56:59], v[132:135], v[112:115], v[56:59]
    ds_read_b64_tr_b16 v[196:197], v6 offset:49152
    v_mfma_f32_16x16x32_bf16 v[60:63], v[132:135], v[116:119], v[60:63]
    ds_read_b64_tr_b16 v[198:199], v6 offset:49664
    v_mfma_f32_16x16x32_bf16 v[72:75], v[132:135], v[120:123], v[72:75]
    ds_read_b128 v[184:187], v4 offset:53248
    v_mfma_f32_16x16x32_bf16 v[76:79], v[132:135], v[124:127], v[76:79]
    ds_read_b64_tr_b16 v[200:201], v8 offset:57344
    v_mfma_f32_16x16x32_bf16 v[80:83], v[112:115], v[136:139], v[80:83]
    ds_read_b64_tr_b16 v[202:203], v8 offset:57856
    v_mfma_f32_16x16x32_bf16 v[84:87], v[116:119], v[136:139], v[84:87]
    ds_read_b128 v[188:191], v4 offset:55296
    v_mfma_f32_16x16x32_bf16 v[96:99], v[120:123], v[136:139], v[96:99]
    ds_read_b64_tr_b16 v[204:205], v6 offset:57344
    v_mfma_f32_16x16x32_bf16 v[100:103], v[124:127], v[136:139], v[100:103]
    ds_read_b64_tr_b16 v[206:207], v6 offset:57856
    v_mfma_f32_16x16x32_bf16 v[88:91], v[112:115], v[140:143], v[88:91]
    ds_read_b128 v[208:211], v5 offset:49152
    v_mfma_f32_16x16x32_bf16 v[92:95], v[116:119], v[140:143], v[92:95]
    ds_read_b64_tr_b16 v[224:225], v8 offset:53248
    v_mfma_f32_16x16x32_bf16 v[104:107], v[120:123], v[140:143], v[104:107]
    ds_read_b64_tr_b16 v[226:227], v8 offset:53760
    v_mfma_f32_16x16x32_bf16 v[108:111], v[124:127], v[140:143], v[108:111]
    ds_read_b128 v[212:215], v5 offset:51200
    v_mfma_f32_16x16x32_bf16 v[48:51], v[160:163], v[144:147], v[48:51]
    ds_read_b64_tr_b16 v[228:229], v6 offset:53248
    v_mfma_f32_16x16x32_bf16 v[52:55], v[160:163], v[148:151], v[52:55]
    ds_read_b64_tr_b16 v[230:231], v6 offset:53760
    v_mfma_f32_16x16x32_bf16 v[64:67], v[160:163], v[152:155], v[64:67]
    ds_read_b128 v[216:219], v5 offset:53248
    v_mfma_f32_16x16x32_bf16 v[68:71], v[160:163], v[156:159], v[68:71]
    ds_read_b64_tr_b16 v[232:233], v8 offset:61440
    v_mfma_f32_16x16x32_bf16 v[56:59], v[164:167], v[144:147], v[56:59]
    ds_read_b64_tr_b16 v[234:235], v8 offset:61952
    v_mfma_f32_16x16x32_bf16 v[60:63], v[164:167], v[148:151], v[60:63]
    ds_read_b128 v[220:223], v5 offset:55296
    v_mfma_f32_16x16x32_bf16 v[72:75], v[164:167], v[152:155], v[72:75]
    ds_read_b64_tr_b16 v[236:237], v6 offset:61440
    v_mfma_f32_16x16x32_bf16 v[76:79], v[164:167], v[156:159], v[76:79]
    ds_read_b64_tr_b16 v[238:239], v6 offset:61952
    v_mfma_f32_16x16x32_bf16 v[80:83], v[144:147], v[168:171], v[80:83]
    v_xor_b32 v248, v13, v248
    v_mfma_f32_16x16x32_bf16 v[84:87], v[148:151], v[168:171], v[84:87]
    v_xor_b32 v249, v13, v249
    v_mfma_f32_16x16x32_bf16 v[96:99], v[152:155], v[168:171], v[96:99]
    v_xor_b32 v250, v13, v250
    v_mfma_f32_16x16x32_bf16 v[100:103], v[156:159], v[168:171], v[100:103]
    v_xor_b32 v251, v13, v251
    v_mfma_f32_16x16x32_bf16 v[88:91], v[144:147], v[172:175], v[88:91]
    v_xor_b32 v252, v13, v252
    v_mfma_f32_16x16x32_bf16 v[92:95], v[148:151], v[172:175], v[92:95]
    v_xor_b32 v253, v13, v253
    v_mfma_f32_16x16x32_bf16 v[104:107], v[152:155], v[172:175], v[104:107]
    v_xor_b32 v254, v13, v254
    v_mfma_f32_16x16x32_bf16 v[108:111], v[156:159], v[172:175], v[108:111]
    v_xor_b32 v255, v13, v255
    s_waitcnt lgkmcnt(0)
    s_nop 0
    v_mfma_f32_16x16x32_bf16 v[48:51], v[192:195], v[176:179], v[48:51]
    v_mov_b32 v36, 0xdddddddd
    v_and_b32 v39, 27, v0
    v_mfma_f32_16x16x32_bf16 v[52:55], v[192:195], v[180:183], v[52:55]
    v_cmp_eq_u32 vcc, 16, v39
    v_mov_b32 v38, 0x3f803f80
    v_mfma_f32_16x16x32_bf16 v[64:67], v[192:195], v[184:187], v[64:67]
    v_mov_b64 v[44:45], -1
    v_cndmask_b32 v38, 0, v38, vcc
    v_mfma_f32_16x16x32_bf16 v[68:71], v[192:195], v[188:191], v[68:71]
    v_mov_b64 v[46:47], -1
    v_mov_b32 v39, v38
    v_mfma_f32_16x16x32_bf16 v[56:59], v[196:199], v[176:179], v[56:59]
    v_mov_b64 v[20:21], v[38:39]
    v_mov_b64 v[22:23], v[38:39]
    v_mfma_f32_16x16x32_bf16 v[60:63], v[196:199], v[180:183], v[60:63]
    v_mov_b64 v[24:25], v[38:39]
    v_mov_b64 v[26:27], v[38:39]
    v_mfma_f32_16x16x32_bf16 v[72:75], v[196:199], v[184:187], v[72:75]
    v_mov_b64 v[28:29], v[38:39]
    v_mov_b64 v[30:31], v[38:39]
    v_mfma_f32_16x16x32_bf16 v[76:79], v[196:199], v[188:191], v[76:79]
    v_mov_b64 v[32:33], v[38:39]
    v_mov_b64 v[34:35], v[38:39]
    v_mfma_f32_16x16x32_bf16 v[80:83], v[176:179], v[200:203], v[80:83]
    v_mov_b64 v[112:113], 0
    v_mov_b64 v[114:115], 0
    v_mfma_f32_16x16x32_bf16 v[84:87], v[180:183], v[200:203], v[84:87]
    v_mov_b64 v[116:117], 0
    v_mov_b64 v[118:119], 0
    v_mfma_f32_16x16x32_bf16 v[96:99], v[184:187], v[200:203], v[96:99]
    v_mov_b64 v[120:121], 0
    v_mov_b64 v[122:123], 0
    v_mfma_f32_16x16x32_bf16 v[100:103], v[188:191], v[200:203], v[100:103]
    v_mov_b64 v[124:125], 0
    v_mov_b64 v[126:127], 0
    v_mfma_f32_16x16x32_bf16 v[88:91], v[176:179], v[204:207], v[88:91]
    v_mov_b64 v[128:129], 0
    v_mov_b64 v[130:131], 0
    v_mfma_f32_16x16x32_bf16 v[92:95], v[180:183], v[204:207], v[92:95]
    v_mov_b64 v[132:133], 0
    v_mov_b64 v[134:135], 0
    v_mfma_f32_16x16x32_bf16 v[104:107], v[184:187], v[204:207], v[104:107]
    v_mov_b64 v[136:137], 0
    v_mov_b64 v[138:139], 0
    v_mfma_f32_16x16x32_bf16 v[108:111], v[188:191], v[204:207], v[108:111]
    v_mov_b64 v[140:141], 0
    v_mov_b64 v[142:143], 0
    v_mfma_f32_16x16x32_bf16 v[48:51], v[224:227], v[208:211], v[48:51]
    v_add_u32 v37, 69632, v1
    v_mov_b64 v[42:43], 0
    v_mfma_f32_16x16x32_bf16 v[52:55], v[224:227], v[212:215], v[52:55]
    v_mfma_f32_16x16x32_bf16 v[64:67], v[224:227], v[216:219], v[64:67]
    v_mfma_f32_16x16x32_bf16 v[68:71], v[224:227], v[220:223], v[68:71]
    v_mfma_f32_16x16x32_bf16 v[56:59], v[228:231], v[208:211], v[56:59]
    v_mfma_f32_16x16x32_bf16 v[60:63], v[228:231], v[212:215], v[60:63]
    v_mfma_f32_16x16x32_bf16 v[72:75], v[228:231], v[216:219], v[72:75]
    v_mfma_f32_16x16x32_bf16 v[76:79], v[228:231], v[220:223], v[76:79]
    v_mfma_f32_16x16x32_bf16 v[80:83], v[208:211], v[232:235], v[80:83]
    v_mfma_f32_16x16x32_bf16 v[84:87], v[212:215], v[232:235], v[84:87]
    v_mfma_f32_16x16x32_bf16 v[96:99], v[216:219], v[232:235], v[96:99]
    v_mfma_f32_16x16x32_bf16 v[100:103], v[220:223], v[232:235], v[100:103]
    v_mfma_f32_16x16x32_bf16 v[88:91], v[208:211], v[236:239], v[88:91]
    v_mfma_f32_16x16x32_bf16 v[92:95], v[212:215], v[236:239], v[92:95]
    v_mfma_f32_16x16x32_bf16 v[104:107], v[216:219], v[236:239], v[104:107]
    v_mfma_f32_16x16x32_bf16 v[108:111], v[220:223], v[236:239], v[108:111]
L_epiB:
    s_xor_b32 s55, s69, 1280
    s_lshl_b32 s55, s55, 11
    s_add_u32 s55, s55, 6291456
    s_add_u32 s56, s55, 131072
    s_xor_b32 s53, s49, 4
    s_lshl_b32 s53, s53, 1
    s_add_u32 s53, s53, s68
    s_lshl_b32 s53, s53, 5
    s_add_u32 s53, s53, s50
    s_lshl_b32 s53, s53, 1
    s_add_u32 s53, s53, s67
    s_lshl_b32 s53, s53, 12
    s_add_u32 s53, s53, 10485760
    s_add_u32 s57, s53, 131072
    v_cvt_pk_bf16_f32 v224, v48, v49
    v_cvt_pk_bf16_f32 v225, v50, v51
    v_cvt_pk_bf16_f32 v226, v52, v53
    v_cvt_pk_bf16_f32 v227, v54, v55
    v_cvt_pk_bf16_f32 v228, v56, v57
    v_cvt_pk_bf16_f32 v229, v58, v59
    v_cvt_pk_bf16_f32 v230, v60, v61
    v_cvt_pk_bf16_f32 v231, v62, v63
    v_permlane16_swap_b32 v224, v226
    v_permlane16_swap_b32 v225, v227
    v_permlane16_swap_b32 v228, v230
    v_permlane16_swap_b32 v229, v231
    v_cvt_pk_bf16_f32 v232, v64, v65
    v_cvt_pk_bf16_f32 v233, v66, v67
    v_mfma_f32_32x32x16_bf16 v[160:175], v[248:251], v[224:227], 0
    v_cvt_pk_bf16_f32 v234, v68, v69
    v_cvt_pk_bf16_f32 v235, v70, v71
    v_cvt_pk_bf16_f32 v236, v72, v73
    v_cvt_pk_bf16_f32 v237, v74, v75
    v_cvt_pk_bf16_f32 v238, v76, v77
    v_cvt_pk_bf16_f32 v239, v78, v79
    v_mfma_f32_32x32x16_bf16 v[176:191], v[252:255], v[228:231], 0
    v_permlane16_swap_b32 v232, v234
    v_permlane16_swap_b32 v233, v235
    v_permlane16_swap_b32 v236, v238
    v_permlane16_swap_b32 v237, v239
    v_cvt_pk_bf16_f32 v144, v80, v81
    v_cvt_pk_bf16_f32 v145, v82, v83
    v_mfma_f32_32x32x16_bf16 v[192:207], v[248:251], v[232:235], 0
    v_cvt_pk_bf16_f32 v146, v84, v85
    v_cvt_pk_bf16_f32 v147, v86, v87
    v_cvt_pk_bf16_f32 v148, v88, v89
    v_cvt_pk_bf16_f32 v149, v90, v91
    v_cvt_pk_bf16_f32 v150, v92, v93
    v_cvt_pk_bf16_f32 v151, v94, v95
    v_mfma_f32_32x32x16_bf16 v[208:223], v[252:255], v[236:239], 0
    v_permlane16_swap_b32 v144, v146
    v_permlane16_swap_b32 v145, v147
    v_permlane16_swap_b32 v148, v150
    v_permlane16_swap_b32 v149, v151
    v_cvt_pk_bf16_f32 v152, v96, v97
    v_cvt_pk_bf16_f32 v153, v98, v99
    v_cvt_pk_bf16_f32 v154, v100, v101
    v_cvt_pk_bf16_f32 v155, v102, v103
    v_cvt_pk_bf16_f32 v156, v104, v105
    v_cvt_pk_bf16_f32 v157, v106, v107
    v_cvt_pk_bf16_f32 v158, v108, v109
    v_cvt_pk_bf16_f32 v159, v110, v111
    v_permlane16_swap_b32 v152, v154
    v_permlane16_swap_b32 v153, v155
    v_permlane16_swap_b32 v156, v158
    v_permlane16_swap_b32 v157, v159
    v_mov_b64 v[104:105], 0
    v_mov_b64 v[106:107], 0
    v_mov_b64 v[108:109], 0
    v_mov_b64 v[110:111], 0
    v_mov_b64 v[224:225], v[244:245]
    v_mov_b64 v[226:227], v[244:245]
    v_mov_b64 v[228:229], v[244:245]
    v_mov_b64 v[230:231], v[244:245]
    v_mov_b64 v[232:233], v[244:245]
    v_mov_b64 v[234:235], v[244:245]
    v_mov_b64 v[236:237], v[244:245]
    v_mov_b64 v[238:239], v[244:245]
    v_max3_f32 v48, v160, v161, v162
    v_max3_f32 v52, v176, v177, v178
    v_max3_f32 v56, v192, v193, v194
    v_max3_f32 v60, v208, v209, v210
    v_max3_f32 v48, v48, v163, v164
    v_max3_f32 v52, v52, v179, v180
    v_max3_f32 v56, v56, v195, v196
    v_max3_f32 v60, v60, v211, v212
    v_max3_f32 v48, v48, v165, v166
    v_max3_f32 v52, v52, v181, v182
    v_max3_f32 v56, v56, v197, v198
    v_max3_f32 v60, v60, v213, v214
    v_max3_f32 v48, v48, v167, v168
    v_max3_f32 v52, v52, v183, v184
    v_max3_f32 v56, v56, v199, v200
    v_max3_f32 v60, v60, v215, v216
    v_max3_f32 v48, v48, v169, v170
    v_max3_f32 v52, v52, v185, v186
    v_max3_f32 v56, v56, v201, v202
    v_max3_f32 v60, v60, v217, v218
    v_max3_f32 v48, v48, v171, v172
    v_max3_f32 v52, v52, v187, v188
    v_max3_f32 v56, v56, v203, v204
    v_max3_f32 v60, v60, v219, v220
    v_max3_f32 v48, v48, v173, v174
    v_max3_f32 v52, v52, v189, v190
    v_max3_f32 v56, v56, v205, v206
    v_max3_f32 v60, v60, v221, v222
    v_max_f32 v48, v48, v175
    v_max_f32 v52, v52, v191
    v_max_f32 v56, v56, v207
    v_max_f32 v60, v60, v223
    v_mul_f32 v48, 0xbfb8aa3b, v48
    v_mul_f32 v52, 0xbfb8aa3b, v52
    v_mul_f32 v56, 0xbfb8aa3b, v56
    v_mul_f32 v60, 0xbfb8aa3b, v60
    v_pk_fma_f32 v[160:161], v[160:161], s[60:61], v[48:49] op_sel_hi:[1,0,0]
    v_pk_fma_f32 v[176:177], v[176:177], s[60:61], v[52:53] op_sel_hi:[1,0,0]
    v_pk_fma_f32 v[192:193], v[192:193], s[60:61], v[56:57] op_sel_hi:[1,0,0]
    v_pk_fma_f32 v[208:209], v[208:209], s[60:61], v[60:61] op_sel_hi:[1,0,0]
    v_pk_fma_f32 v[162:163], v[162:163], s[60:61], v[48:49] op_sel_hi:[1,0,0]
    v_pk_fma_f32 v[178:179], v[178:179], s[60:61], v[52:53] op_sel_hi:[1,0,0]
    v_pk_fma_f32 v[194:195], v[194:195], s[60:61], v[56:57] op_sel_hi:[1,0,0]
    v_pk_fma_f32 v[210:211], v[210:211], s[60:61], v[60:61] op_sel_hi:[1,0,0]
    v_pk_fma_f32 v[164:165], v[164:165], s[60:61], v[48:49] op_sel_hi:[1,0,0]
    v_pk_fma_f32 v[180:181], v[180:181], s[60:61], v[52:53] op_sel_hi:[1,0,0]
    v_pk_fma_f32 v[196:197], v[196:197], s[60:61], v[56:57] op_sel_hi:[1,0,0]
    v_pk_fma_f32 v[212:213], v[212:213], s[60:61], v[60:61] op_sel_hi:[1,0,0]
    v_pk_fma_f32 v[166:167], v[166:167], s[60:61], v[48:49] op_sel_hi:[1,0,0]
    v_pk_fma_f32 v[182:183], v[182:183], s[60:61], v[52:53] op_sel_hi:[1,0,0]
    v_pk_fma_f32 v[198:199], v[198:199], s[60:61], v[56:57] op_sel_hi:[1,0,0]
    v_pk_fma_f32 v[214:215], v[214:215], s[60:61], v[60:61] op_sel_hi:[1,0,0]
    v_pk_fma_f32 v[168:169], v[168:169], s[60:61], v[48:49] op_sel_hi:[1,0,0]
    v_pk_fma_f32 v[184:185], v[184:185], s[60:61], v[52:53] op_sel_hi:[1,0,0]
    v_pk_fma_f32 v[200:201], v[200:201], s[60:61], v[56:57] op_sel_hi:[1,0,0]
    v_pk_fma_f32 v[216:217], v[216:217], s[60:61], v[60:61] op_sel_hi:[1,0,0]
    v_pk_fma_f32 v[170:171], v[170:171], s[60:61], v[48:49] op_sel_hi:[1,0,0]
    v_pk_fma_f32 v[186:187], v[186:187], s[60:61], v[52:53] op_sel_hi:[1,0,0]
    v_pk_fma_f32 v[202:203], v[202:203], s[60:61], v[56:57] op_sel_hi:[1,0,0]
    v_pk_fma_f32 v[218:219], v[218:219], s[60:61], v[60:61] op_sel_hi:[1,0,0]
    v_pk_fma_f32 v[172:173], v[172:173], s[60:61], v[48:49] op_sel_hi:[1,0,0]
    v_pk_fma_f32 v[188:189], v[188:189], s[60:61], v[52:53] op_sel_hi:[1,0,0]
    v_pk_fma_f32 v[204:205], v[204:205], s[60:61], v[56:57] op_sel_hi:[1,0,0]
    v_pk_fma_f32 v[220:221], v[220:221], s[60:61], v[60:61] op_sel_hi:[1,0,0]
    v_pk_fma_f32 v[174:175], v[174:175], s[60:61], v[48:49] op_sel_hi:[1,0,0]
    v_pk_fma_f32 v[190:191], v[190:191], s[60:61], v[52:53] op_sel_hi:[1,0,0]
    v_pk_fma_f32 v[206:207], v[206:207], s[60:61], v[56:57] op_sel_hi:[1,0,0]
    v_pk_fma_f32 v[222:223], v[222:223], s[60:61], v[60:61] op_sel_hi:[1,0,0]
    v_exp_f32 v160, v160
    v_exp_f32 v176, v176
    v_exp_f32 v192, v192
    v_exp_f32 v208, v208
    v_exp_f32 v161, v161
    v_exp_f32 v177, v177
    v_exp_f32 v193, v193
    v_exp_f32 v209, v209
    v_exp_f32 v162, v162
    v_exp_f32 v178, v178
    v_exp_f32 v194, v194
    v_exp_f32 v210, v210
    v_exp_f32 v163, v163
    v_exp_f32 v179, v179
    v_exp_f32 v195, v195
    v_exp_f32 v211, v211
    v_exp_f32 v164, v164
    v_exp_f32 v180, v180
    v_exp_f32 v196, v196
    v_exp_f32 v212, v212
    v_exp_f32 v165, v165
    v_exp_f32 v181, v181
    v_exp_f32 v197, v197
    v_exp_f32 v213, v213
    v_exp_f32 v166, v166
    v_exp_f32 v182, v182
    v_exp_f32 v198, v198
    v_exp_f32 v214, v214
    v_exp_f32 v167, v167
    v_exp_f32 v183, v183
    v_exp_f32 v199, v199
    v_exp_f32 v215, v215
    v_exp_f32 v168, v168
    v_exp_f32 v184, v184
    v_exp_f32 v200, v200
    v_exp_f32 v216, v216
    v_exp_f32 v169, v169
    v_exp_f32 v185, v185
    v_exp_f32 v201, v201
    v_exp_f32 v217, v217
    v_exp_f32 v170, v170
    v_exp_f32 v186, v186
    v_exp_f32 v202, v202
    v_exp_f32 v218, v218
    v_exp_f32 v171, v171
    v_exp_f32 v187, v187
    v_exp_f32 v203, v203
    v_exp_f32 v219, v219
    v_exp_f32 v172, v172
    v_exp_f32 v188, v188
    v_exp_f32 v204, v204
    v_exp_f32 v220, v220
    v_exp_f32 v173, v173
    v_exp_f32 v189, v189
    v_exp_f32 v205, v205
    v_exp_f32 v221, v221
    v_exp_f32 v174, v174
    v_exp_f32 v190, v190
    v_exp_f32 v206, v206
    v_exp_f32 v222, v222
    v_exp_f32 v175, v175
    v_exp_f32 v191, v191
    v_exp_f32 v207, v207
    v_exp_f32 v223, v223
    v_pk_add_f32 v[50:51], v[160:161], v[162:163]
    v_pk_add_f32 v[54:55], v[176:177], v[178:179]
    v_pk_add_f32 v[58:59], v[192:193], v[194:195]
    v_pk_add_f32 v[62:63], v[208:209], v[210:211]
    v_pk_add_f32 v[50:51], v[50:51], v[164:165]
    v_pk_add_f32 v[54:55], v[54:55], v[180:181]
    v_pk_add_f32 v[58:59], v[58:59], v[196:197]
    v_pk_add_f32 v[62:63], v[62:63], v[212:213]
    v_pk_add_f32 v[50:51], v[50:51], v[166:167]
    v_pk_add_f32 v[54:55], v[54:55], v[182:183]
    v_pk_add_f32 v[58:59], v[58:59], v[198:199]
    v_pk_add_f32 v[62:63], v[62:63], v[214:215]
    v_pk_add_f32 v[50:51], v[50:51], v[168:169]
    v_pk_add_f32 v[54:55], v[54:55], v[184:185]
    v_pk_add_f32 v[58:59], v[58:59], v[200:201]
    v_pk_add_f32 v[62:63], v[62:63], v[216:217]
    v_pk_add_f32 v[50:51], v[50:51], v[170:171]
    v_pk_add_f32 v[54:55], v[54:55], v[186:187]
    v_pk_add_f32 v[58:59], v[58:59], v[202:203]
    v_pk_add_f32 v[62:63], v[62:63], v[218:219]
    v_pk_add_f32 v[50:51], v[50:51], v[172:173]
    v_pk_add_f32 v[54:55], v[54:55], v[188:189]
    v_pk_add_f32 v[58:59], v[58:59], v[204:205]
    v_pk_add_f32 v[62:63], v[62:63], v[220:221]
    v_pk_add_f32 v[50:51], v[50:51], v[174:175]
    v_pk_add_f32 v[54:55], v[54:55], v[190:191]
    v_pk_add_f32 v[58:59], v[58:59], v[206:207]
    v_pk_add_f32 v[62:63], v[62:63], v[222:223]
    v_add_f32 v48, v50, v51
    v_add_f32 v52, v54, v55
    v_add_f32 v56, v58, v59
    v_add_f32 v60, v62, v63
    v_rcp_f32 v48, v48
    v_rcp_f32 v52, v52
    v_rcp_f32 v56, v56
    v_rcp_f32 v60, v60
    v_pk_mul_f32 v[160:161], v[160:161], v[48:49] op_sel_hi:[1,0]
    v_pk_mul_f32 v[176:177], v[176:177], v[52:53] op_sel_hi:[1,0]
    v_pk_mul_f32 v[192:193], v[192:193], v[56:57] op_sel_hi:[1,0]
    v_pk_mul_f32 v[208:209], v[208:209], v[60:61] op_sel_hi:[1,0]
    v_pk_mul_f32 v[162:163], v[162:163], v[48:49] op_sel_hi:[1,0]
    v_pk_mul_f32 v[178:179], v[178:179], v[52:53] op_sel_hi:[1,0]
    v_pk_mul_f32 v[194:195], v[194:195], v[56:57] op_sel_hi:[1,0]
    v_pk_mul_f32 v[210:211], v[210:211], v[60:61] op_sel_hi:[1,0]
    v_pk_mul_f32 v[164:165], v[164:165], v[48:49] op_sel_hi:[1,0]
    v_pk_mul_f32 v[180:181], v[180:181], v[52:53] op_sel_hi:[1,0]
    v_pk_mul_f32 v[196:197], v[196:197], v[56:57] op_sel_hi:[1,0]
    v_pk_mul_f32 v[212:213], v[212:213], v[60:61] op_sel_hi:[1,0]
    v_pk_mul_f32 v[166:167], v[166:167], v[48:49] op_sel_hi:[1,0]
    v_pk_mul_f32 v[182:183], v[182:183], v[52:53] op_sel_hi:[1,0]
    v_pk_mul_f32 v[198:199], v[198:199], v[56:57] op_sel_hi:[1,0]
    v_pk_mul_f32 v[214:215], v[214:215], v[60:61] op_sel_hi:[1,0]
    v_pk_mul_f32 v[168:169], v[168:169], v[48:49] op_sel_hi:[1,0]
    v_pk_mul_f32 v[184:185], v[184:185], v[52:53] op_sel_hi:[1,0]
    v_pk_mul_f32 v[200:201], v[200:201], v[56:57] op_sel_hi:[1,0]
    v_pk_mul_f32 v[216:217], v[216:217], v[60:61] op_sel_hi:[1,0]
    v_pk_mul_f32 v[170:171], v[170:171], v[48:49] op_sel_hi:[1,0]
    v_pk_mul_f32 v[186:187], v[186:187], v[52:53] op_sel_hi:[1,0]
    v_pk_mul_f32 v[202:203], v[202:203], v[56:57] op_sel_hi:[1,0]
    v_pk_mul_f32 v[218:219], v[218:219], v[60:61] op_sel_hi:[1,0]
    v_pk_mul_f32 v[172:173], v[172:173], v[48:49] op_sel_hi:[1,0]
    v_pk_mul_f32 v[188:189], v[188:189], v[52:53] op_sel_hi:[1,0]
    v_pk_mul_f32 v[204:205], v[204:205], v[56:57] op_sel_hi:[1,0]
    v_pk_mul_f32 v[220:221], v[220:221], v[60:61] op_sel_hi:[1,0]
    v_pk_mul_f32 v[174:175], v[174:175], v[48:49] op_sel_hi:[1,0]
    v_pk_mul_f32 v[190:191], v[190:191], v[52:53] op_sel_hi:[1,0]
    v_pk_mul_f32 v[206:207], v[206:207], v[56:57] op_sel_hi:[1,0]
    v_pk_mul_f32 v[222:223], v[222:223], v[60:61] op_sel_hi:[1,0]
    v_cvt_pk_bf16_f32 v160, v160, v161
    v_cvt_pk_bf16_f32 v176, v176, v177
    v_cvt_pk_bf16_f32 v192, v192, v193
    v_cvt_pk_bf16_f32 v208, v208, v209
    v_cvt_pk_bf16_f32 v161, v162, v163
    v_cvt_pk_bf16_f32 v177, v178, v179
    v_cvt_pk_bf16_f32 v193, v194, v195
    v_cvt_pk_bf16_f32 v209, v210, v211
    v_cvt_pk_bf16_f32 v162, v164, v165
    v_cvt_pk_bf16_f32 v178, v180, v181
    v_cvt_pk_bf16_f32 v194, v196, v197
    v_cvt_pk_bf16_f32 v210, v212, v213
    v_cvt_pk_bf16_f32 v163, v166, v167
    v_cvt_pk_bf16_f32 v179, v182, v183
    v_cvt_pk_bf16_f32 v195, v198, v199
    v_cvt_pk_bf16_f32 v211, v214, v215
    v_cvt_pk_bf16_f32 v164, v168, v169
    v_cvt_pk_bf16_f32 v180, v184, v185
    v_cvt_pk_bf16_f32 v196, v200, v201
    v_cvt_pk_bf16_f32 v212, v216, v217
    v_cvt_pk_bf16_f32 v165, v170, v171
    v_cvt_pk_bf16_f32 v181, v186, v187
    v_cvt_pk_bf16_f32 v197, v202, v203
    v_cvt_pk_bf16_f32 v213, v218, v219
    v_cvt_pk_bf16_f32 v166, v172, v173
    v_cvt_pk_bf16_f32 v182, v188, v189
    v_cvt_pk_bf16_f32 v198, v204, v205
    v_cvt_pk_bf16_f32 v214, v220, v221
    v_cvt_pk_bf16_f32 v167, v174, v175
    v_cvt_pk_bf16_f32 v183, v190, v191
    v_cvt_pk_bf16_f32 v199, v206, v207
    v_cvt_pk_bf16_f32 v215, v222, v223
    s_sub_u32 s54, s8, 6293504
    s_lshr_b32 s54, s54, 1
    s_lshl_b32 s67, s26, 17
    s_add_u32 s67, s67, 2097152
    s_lshl_b32 s66, s48, 12
    s_add_u32 s66, s66, 61440
    s_barrier
    s_setprio 3
    buffer_load_dwordx4 v[4:7], v1, s[40:43], s54 offen sc1
    buffer_load_dwordx4 v[8:11], v1, s[40:43], s54 offen offset:1024 sc1
    ds_read_b64 v[38:39], v243
    ds_read_b128 v[12:15], v37
    s_mov_b64 exec, s[62:63]
    ds_read_b128 v[20:23], v37 offset:1024
    ds_read_b128 v[24:27], v37 offset:1280
    s_mov_b64 exec, -1
    v_subrev_u32 v37, 8192, v37
    s_bitcmp1_b32 s2, 5
    s_cbranch_scc1 L_kv
    s_waitcnt lgkmcnt(0)
    v_mov_b32 v40, v38
    v_mov_b32 v41, v38
    v_mov_b64 v[48:49], v[40:41]
    v_mov_b64 v[50:51], v[40:41]
    v_mov_b64 v[52:53], v[40:41]
    v_mov_b64 v[54:55], v[40:41]
    v_mov_b64 v[56:57], v[40:41]
    v_mov_b64 v[58:59], v[40:41]
    v_mov_b64 v[60:61], v[40:41]
    v_mov_b64 v[62:63], v[40:41]
    v_mov_b32 v38, v39
    v_mov_b64 v[64:65], v[38:39]
    v_mov_b64 v[66:67], v[38:39]
    v_mov_b64 v[68:69], v[38:39]
    v_mov_b64 v[70:71], v[38:39]
    v_mov_b64 v[72:73], v[38:39]
    v_mov_b64 v[74:75], v[38:39]
    v_mov_b64 v[76:77], v[38:39]
    v_mov_b64 v[78:79], v[38:39]
    s_waitcnt vmcnt(0)
    v_mfma_f32_32x32x16_bf16 v[80:95], v[12:15], v[4:7], v[48:63]
    buffer_store_dwordx4 v[160:163], v1, s[40:43], s55 offen offset:0 sc1
    buffer_store_dwordx4 v[164:167], v1, s[40:43], s55 offen offset:1024 sc1
    buffer_store_dwordx4 v[192:195], v1, s[40:43], s55 offen offset:2048 sc1
    buffer_store_dwordx4 v[196:199], v1, s[40:43], s55 offen offset:3072 sc1
    buffer_store_dwordx4 v[176:179], v1, s[40:43], s56 offen offset:0 sc1
    buffer_store_dwordx4 v[180:183], v1, s[40:43], s56 offen offset:1024 sc1
    buffer_store_dwordx4 v[208:211], v1, s[40:43], s56 offen offset:2048 sc1
    buffer_store_dwordx4 v[212:215], v1, s[40:43], s56 offen offset:3072 sc1
    s_nop 1
    s_branch L_slot2
L_kv:
    ds_write_b128 v240, v[160:163] offset:0
    ds_write_b128 v241, v[164:167] offset:0
    ds_write_b128 v240, v[192:195] offset:2048
    ds_write_b128 v241, v[196:199] offset:2048
    ds_read_b64_tr_b16 v[168:169], v242 offset:0
    ds_read_b64_tr_b16 v[170:171], v246 offset:256
    ds_read_b64_tr_b16 v[172:173], v242 offset:1024
    ds_read_b64_tr_b16 v[174:175], v246 offset:1280
    ds_read_b64_tr_b16 v[200:201], v242 offset:2048
    ds_read_b64_tr_b16 v[202:203], v246 offset:2304
    ds_read_b64_tr_b16 v[204:205], v242 offset:3072
    ds_read_b64_tr_b16 v[206:207], v246 offset:3328
    v_permlane16_swap_b32 v144, v224
    v_permlane16_swap_b32 v145, v225
    v_permlane16_swap_b32 v146, v226
    v_permlane16_swap_b32 v147, v227
    v_permlane16_swap_b32 v148, v228
    v_permlane16_swap_b32 v149, v229
    v_permlane16_swap_b32 v150, v230
    v_permlane16_swap_b32 v151, v231
    ds_write_b128 v240, v[176:179] offset:0
    ds_write_b128 v241, v[180:183] offset:0
    ds_write_b128 v240, v[208:211] offset:2048
    ds_write_b128 v241, v[212:215] offset:2048
    ds_read_b64_tr_b16 v[184:185], v242 offset:0
    ds_read_b64_tr_b16 v[186:187], v246 offset:256
    ds_read_b64_tr_b16 v[188:189], v242 offset:1024
    ds_read_b64_tr_b16 v[190:191], v246 offset:1280
    ds_read_b64_tr_b16 v[216:217], v242 offset:2048
    ds_read_b64_tr_b16 v[218:219], v246 offset:2304
    ds_read_b64_tr_b16 v[220:221], v242 offset:3072
    ds_read_b64_tr_b16 v[222:223], v246 offset:3328
    v_permlane16_swap_b32 v152, v232
    v_permlane16_swap_b32 v153, v233
    v_permlane16_swap_b32 v154, v234
    v_permlane16_swap_b32 v155, v235
    v_permlane16_swap_b32 v156, v236
    v_permlane16_swap_b32 v157, v237
    v_permlane16_swap_b32 v158, v238
    v_permlane16_swap_b32 v159, v239
    s_waitcnt lgkmcnt(0)
    v_mfma_f32_32x32x16_bf16 v[80:95], v[168:171], v[144:147], 0
    v_mov_b32 v40, v38
    v_mov_b32 v41, v38
    v_mov_b64 v[48:49], v[40:41]
    v_mfma_f32_32x32x16_bf16 v[80:95], v[172:175], v[224:227], v[80:95]
    v_mov_b64 v[50:51], v[40:41]
    v_mov_b64 v[52:53], v[40:41]
    v_mov_b64 v[54:55], v[40:41]
    v_mfma_f32_32x32x16_bf16 v[80:95], v[200:203], v[152:155], v[80:95]
    v_mov_b64 v[56:57], v[40:41]
    v_mov_b64 v[58:59], v[40:41]
    v_mov_b64 v[60:61], v[40:41]
    v_mfma_f32_32x32x16_bf16 v[80:95], v[204:207], v[232:235], v[80:95]
    v_mov_b64 v[62:63], v[40:41]
    v_mov_b32 v38, v39
    v_mov_b64 v[64:65], v[38:39]
    v_mfma_f32_32x32x16_bf16 v[160:175], v[184:187], v[148:151], 0
    v_mov_b64 v[66:67], v[38:39]
    v_mov_b64 v[68:69], v[38:39]
    v_mov_b64 v[70:71], v[38:39]
    v_mfma_f32_32x32x16_bf16 v[160:175], v[188:191], v[228:231], v[160:175]
    v_mov_b64 v[72:73], v[38:39]
    v_mov_b64 v[74:75], v[38:39]
    v_mov_b64 v[76:77], v[38:39]
    v_mfma_f32_32x32x16_bf16 v[160:175], v[216:219], v[156:159], v[160:175]
    v_mov_b64 v[78:79], v[38:39]
    v_mfma_f32_32x32x16_bf16 v[160:175], v[220:223], v[236:239], v[160:175]
    buffer_store_dwordx4 v[80:83], v1, s[40:43], s53 offen offset:0 sc1
    buffer_store_dwordx4 v[84:87], v1, s[40:43], s53 offen offset:1024 sc1
    buffer_store_dwordx4 v[88:91], v1, s[40:43], s53 offen offset:2048 sc1
    buffer_store_dwordx4 v[92:95], v1, s[40:43], s53 offen offset:3072 sc1
    s_waitcnt vmcnt(4)
    s_nop 0
    v_mfma_f32_32x32x16_bf16 v[80:95], v[12:15], v[4:7], v[48:63]
    s_nop 4
    buffer_store_dwordx4 v[160:163], v1, s[40:43], s57 offen offset:0 sc1
    buffer_store_dwordx4 v[164:167], v1, s[40:43], s57 offen offset:1024 sc1
    buffer_store_dwordx4 v[168:171], v1, s[40:43], s57 offen offset:2048 sc1
    buffer_store_dwordx4 v[172:175], v1, s[40:43], s57 offen offset:3072 sc1
    s_nop 1
    s_branch L_slot2
.p2align 6
L_slot0:
    s_setprio 3
    ds_read_b128 v[16:19], v37 offset:2048
    v_exp_f32 v80, v80
    v_exp_f32 v81, v81
    v_smfmac_f32_32x32x32_bf16 v[128:143], v[32:35], v[104:111], v36
    v_exp_f32 v82, v82
    v_exp_f32 v83, v83
    v_exp_f32 v84, v84
    v_mfma_f32_32x32x16_bf16 v[96:111], v[12:15], v[8:11], v[64:79]
    s_mov_b64 exec, s[62:63]
    ds_read_b128 v[28:31], v37 offset:3072
    ds_read_b128 v[32:35], v37 offset:3328
    s_mov_b64 exec, -1
    v_exp_f32 v85, v85
    v_exp_f32 v86, v86
    v_exp_f32 v87, v87
    v_exp_f32 v88, v88
    v_exp_f32 v89, v89
    v_exp_f32 v90, v90
    v_exp_f32 v91, v91
    v_smfmac_f32_32x32x32_bf16 v[112:127], v[20:23], v[80:87], v36
    v_exp_f32 v92, v92
    v_exp_f32 v93, v93
    v_exp_f32 v94, v94
    v_exp_f32 v95, v95
    v_exp_f32 v96, v96
    v_exp_f32 v97, v97
    v_smfmac_f32_32x32x32_bf16 v[112:127], v[24:27], v[88:95], v36
    v_exp_f32 v98, v98
    v_exp_f32 v99, v99
    v_exp_f32 v100, v100
    s_waitcnt lgkmcnt(0)
    v_mfma_f32_32x32x16_bf16 v[80:95], v[16:19], v[4:7], v[48:63]
    v_exp_f32 v101, v101
    v_exp_f32 v102, v102
    v_exp_f32 v103, v103
    v_exp_f32 v104, v104
    v_exp_f32 v105, v105
    v_exp_f32 v106, v106
    v_exp_f32 v107, v107
    v_smfmac_f32_32x32x32_bf16 v[128:143], v[20:23], v[96:103], v36
    v_exp_f32 v108, v108
    v_exp_f32 v109, v109
    v_exp_f32 v110, v110
    v_exp_f32 v111, v111
    ds_read_b128 v[12:15], v37 offset:4096
    v_exp_f32 v80, v80
    v_exp_f32 v81, v81
    v_smfmac_f32_32x32x32_bf16 v[128:143], v[24:27], v[104:111], v36
    v_exp_f32 v82, v82
    v_exp_f32 v83, v83
    v_exp_f32 v84, v84
    v_mfma_f32_32x32x16_bf16 v[96:111], v[16:19], v[8:11], v[64:79]
    s_mov_b64 exec, s[62:63]
    ds_read_b128 v[20:23], v37 offset:5120
    ds_read_b128 v[24:27], v37 offset:5376
    s_mov_b64 exec, -1
    v_exp_f32 v85, v85
    v_exp_f32 v86, v86
    v_exp_f32 v87, v87
    v_exp_f32 v88, v88
    v_exp_f32 v89, v89
    v_exp_f32 v90, v90
    v_exp_f32 v91, v91
    v_smfmac_f32_32x32x32_bf16 v[112:127], v[28:31], v[80:87], v36
    v_exp_f32 v92, v92
    v_exp_f32 v93, v93
    v_exp_f32 v94, v94
    v_exp_f32 v95, v95
    v_exp_f32 v96, v96
    v_exp_f32 v97, v97
    v_smfmac_f32_32x32x32_bf16 v[112:127], v[32:35], v[88:95], v36
    v_exp_f32 v98, v98
    v_exp_f32 v99, v99
    v_exp_f32 v100, v100
    s_waitcnt lgkmcnt(0)
    v_mfma_f32_32x32x16_bf16 v[80:95], v[12:15], v[4:7], v[48:63]
    v_exp_f32 v101, v101
    v_exp_f32 v102, v102
    v_exp_f32 v103, v103
    v_exp_f32 v104, v104
    v_exp_f32 v105, v105
    v_exp_f32 v106, v106
    v_exp_f32 v107, v107
    v_smfmac_f32_32x32x32_bf16 v[128:143], v[28:31], v[96:103], v36
    v_exp_f32 v108, v108
    v_exp_f32 v109, v109
    v_exp_f32 v110, v110
    v_exp_f32 v111, v111
L_slot1:
    s_setprio 3
    ds_read_b128 v[16:19], v37 offset:6144
    v_exp_f32 v80, v80
    v_exp_f32 v81, v81
    v_smfmac_f32_32x32x32_bf16 v[128:143], v[32:35], v[104:111], v36
    v_exp_f32 v82, v82
    v_exp_f32 v83, v83
    v_exp_f32 v84, v84
    v_mfma_f32_32x32x16_bf16 v[96:111], v[12:15], v[8:11], v[64:79]
    s_mov_b64 exec, s[62:63]
    ds_read_b128 v[28:31], v37 offset:7168
    ds_read_b128 v[32:35], v37 offset:7424
    s_mov_b64 exec, -1
    v_exp_f32 v85, v85
    v_exp_f32 v86, v86
    v_exp_f32 v87, v87
    v_exp_f32 v88, v88
    v_exp_f32 v89, v89
    v_exp_f32 v90, v90
    v_exp_f32 v91, v91
    v_smfmac_f32_32x32x32_bf16 v[112:127], v[20:23], v[80:87], v36
    v_exp_f32 v92, v92
    v_exp_f32 v93, v93
    v_exp_f32 v94, v94
    v_exp_f32 v95, v95
    v_exp_f32 v96, v96
    v_exp_f32 v97, v97
    v_smfmac_f32_32x32x32_bf16 v[112:127], v[24:27], v[88:95], v36
    v_exp_f32 v98, v98
    v_exp_f32 v99, v99
    v_exp_f32 v100, v100
    s_waitcnt lgkmcnt(0)
    v_mfma_f32_32x32x16_bf16 v[80:95], v[16:19], v[4:7], v[48:63]
    v_exp_f32 v101, v101
    v_exp_f32 v102, v102
    v_exp_f32 v103, v103
    v_exp_f32 v104, v104
    v_exp_f32 v105, v105
    v_exp_f32 v106, v106
    v_exp_f32 v107, v107
    v_smfmac_f32_32x32x32_bf16 v[128:143], v[20:23], v[96:103], v36
    v_exp_f32 v108, v108
    v_exp_f32 v109, v109
    v_exp_f32 v110, v110
    ds_write_b128 v162, v[180:183]
    v_exp_f32 v111, v111
    ds_read_b128 v[12:15], v37 offset:8192
    v_exp_f32 v80, v80
    v_exp_f32 v81, v81
    v_smfmac_f32_32x32x32_bf16 v[128:143], v[24:27], v[104:111], v36
    v_exp_f32 v82, v82
    v_exp_f32 v83, v83
    v_exp_f32 v84, v84
    v_mfma_f32_32x32x16_bf16 v[96:111], v[16:19], v[8:11], v[64:79]
    s_mov_b64 exec, s[62:63]
    ds_read_b128 v[20:23], v37 offset:9216
    ds_read_b128 v[24:27], v37 offset:9472
    s_mov_b64 exec, -1
    v_exp_f32 v85, v85
    v_exp_f32 v86, v86
    v_exp_f32 v87, v87
    v_exp_f32 v88, v88
    ds_read_b64_tr_b16 v[144:145], v153
    ds_read_b64_tr_b16 v[146:147], v153 offset:512
    v_exp_f32 v89, v89
    v_exp_f32 v90, v90
    v_exp_f32 v91, v91
    v_smfmac_f32_32x32x32_bf16 v[112:127], v[28:31], v[80:87], v36
    v_exp_f32 v92, v92
    v_exp_f32 v93, v93
    v_exp_f32 v94, v94
    v_exp_f32 v95, v95
    v_exp_f32 v96, v96
    v_exp_f32 v97, v97
    v_smfmac_f32_32x32x32_bf16 v[112:127], v[32:35], v[88:95], v36
    v_exp_f32 v98, v98
    v_exp_f32 v99, v99
    v_exp_f32 v100, v100
    s_waitcnt lgkmcnt(0)
    v_mfma_f32_32x32x16_bf16 v[80:95], v[12:15], v[4:7], v[48:63]
    v_exp_f32 v101, v101
    v_exp_f32 v102, v102
    v_exp_f32 v103, v103
    v_exp_f32 v104, v104
    v_exp_f32 v105, v105
    v_exp_f32 v106, v106
    buffer_store_dwordx4 v[144:147], v1, s[40:43], s61 offen sc1
    v_exp_f32 v107, v107
    v_smfmac_f32_32x32x32_bf16 v[128:143], v[28:31], v[96:103], v36
    v_exp_f32 v108, v108
    s_mov_b32 exec_lo, 1
    s_mov_b32 exec_hi, 1
    buffer_store_dword v156, v163, s[40:43], s60 offen sc1
    s_mov_b64 exec, -1
    v_exp_f32 v109, v109
    v_exp_f32 v110, v110
    v_exp_f32 v111, v111
L_slot2:
    s_setprio 2
    ds_read_b128 v[16:19], v37 offset:10240
    v_exp_f32 v80, v80
    v_exp_f32 v81, v81
    v_smfmac_f32_32x32x32_bf16 v[128:143], v[32:35], v[104:111], v36
    v_exp_f32 v82, v82
    v_exp_f32 v83, v83
    v_exp_f32 v84, v84
    v_mfma_f32_32x32x16_bf16 v[96:111], v[12:15], v[8:11], v[64:79]
    s_mov_b64 exec, s[62:63]
    ds_read_b128 v[28:31], v37 offset:11264
    ds_read_b128 v[32:35], v37 offset:11520
    s_mov_b64 exec, -1
    v_exp_f32 v85, v85
    v_exp_f32 v86, v86
    v_exp_f32 v87, v87
    v_exp_f32 v88, v88
    v_exp_f32 v89, v89
    v_exp_f32 v90, v90
    v_exp_f32 v91, v91
    v_smfmac_f32_32x32x32_bf16 v[112:127], v[20:23], v[80:87], v36
    v_exp_f32 v92, v92
    v_exp_f32 v93, v93
    v_exp_f32 v94, v94
    v_exp_f32 v95, v95
    v_exp_f32 v96, v96
    v_exp_f32 v97, v97
    v_smfmac_f32_32x32x32_bf16 v[112:127], v[24:27], v[88:95], v36
    v_exp_f32 v98, v98
    v_exp_f32 v99, v99
    v_exp_f32 v100, v100
    s_waitcnt lgkmcnt(0)
    v_mfma_f32_32x32x16_bf16 v[80:95], v[16:19], v[4:7], v[48:63]
    v_exp_f32 v101, v101
    v_exp_f32 v102, v102
    v_exp_f32 v103, v103
    v_exp_f32 v104, v104
    v_exp_f32 v105, v105
    v_exp_f32 v106, v106
    v_exp_f32 v107, v107
    v_smfmac_f32_32x32x32_bf16 v[128:143], v[20:23], v[96:103], v36
    v_exp_f32 v108, v108
    v_exp_f32 v109, v109
    v_exp_f32 v110, v110
    v_exp_f32 v111, v111
    ds_read_b128 v[12:15], v37 offset:12288
    v_exp_f32 v80, v80
    v_exp_f32 v81, v81
    v_smfmac_f32_32x32x32_bf16 v[128:143], v[24:27], v[104:111], v36
    v_exp_f32 v82, v82
    v_exp_f32 v83, v83
    v_exp_f32 v84, v84
    v_mfma_f32_32x32x16_bf16 v[96:111], v[16:19], v[8:11], v[64:79]
    s_mov_b64 exec, s[62:63]
    ds_read_b128 v[20:23], v37 offset:13312
    ds_read_b128 v[24:27], v37 offset:13568
    s_mov_b64 exec, -1
    v_exp_f32 v85, v85
    v_exp_f32 v86, v86
    v_exp_f32 v87, v87
    v_exp_f32 v88, v88
    v_exp_f32 v89, v89
    v_exp_f32 v90, v90
    v_exp_f32 v91, v91
    v_smfmac_f32_32x32x32_bf16 v[112:127], v[28:31], v[80:87], v36
    v_exp_f32 v92, v92
    v_exp_f32 v93, v93
    v_exp_f32 v94, v94
    v_exp_f32 v95, v95
    v_exp_f32 v96, v96
    v_exp_f32 v97, v97
    v_smfmac_f32_32x32x32_bf16 v[112:127], v[32:35], v[88:95], v36
    v_exp_f32 v98, v98
    v_exp_f32 v99, v99
    v_exp_f32 v100, v100
    s_waitcnt lgkmcnt(0)
    v_mfma_f32_32x32x16_bf16 v[80:95], v[12:15], v[4:7], v[48:63]
    v_exp_f32 v101, v101
    v_exp_f32 v102, v102
    v_exp_f32 v103, v103
    v_exp_f32 v104, v104
    v_exp_f32 v105, v105
    v_exp_f32 v106, v106
    v_exp_f32 v107, v107
    v_smfmac_f32_32x32x32_bf16 v[128:143], v[28:31], v[96:103], v36
    v_exp_f32 v108, v108
    v_exp_f32 v109, v109
    v_exp_f32 v110, v110
    v_exp_f32 v111, v111
L_slot3:
    s_setprio 2
    ds_read_b128 v[16:19], v37 offset:14336
    v_exp_f32 v80, v80
    v_exp_f32 v81, v81
    v_smfmac_f32_32x32x32_bf16 v[128:143], v[32:35], v[104:111], v36
    v_exp_f32 v82, v82
    v_exp_f32 v83, v83
    v_exp_f32 v84, v84
    v_mfma_f32_32x32x16_bf16 v[96:111], v[12:15], v[8:11], v[64:79]
    s_mov_b64 exec, s[62:63]
    ds_read_b128 v[28:31], v37 offset:15360
    ds_read_b128 v[32:35], v37 offset:15616
    s_mov_b64 exec, -1
    v_exp_f32 v85, v85
    v_exp_f32 v86, v86
    v_exp_f32 v87, v87
    v_exp_f32 v88, v88
    v_exp_f32 v89, v89
    v_exp_f32 v90, v90
    buffer_store_dwordx4 v[44:47], v1, s[40:43], s4 offen sc1
    v_exp_f32 v91, v91
    v_smfmac_f32_32x32x32_bf16 v[112:127], v[20:23], v[80:87], v36
    v_exp_f32 v92, v92
    v_exp_f32 v93, v93
    v_exp_f32 v94, v94
    v_exp_f32 v95, v95
    v_exp_f32 v96, v96
    v_exp_f32 v97, v97
    v_smfmac_f32_32x32x32_bf16 v[112:127], v[24:27], v[88:95], v36
    v_exp_f32 v98, v98
    v_exp_f32 v99, v99
    v_exp_f32 v100, v100
    s_waitcnt lgkmcnt(0)
    v_mfma_f32_32x32x16_bf16 v[80:95], v[16:19], v[4:7], v[48:63]
    v_exp_f32 v101, v101
    v_exp_f32 v102, v102
    v_exp_f32 v103, v103
    v_exp_f32 v104, v104
    v_exp_f32 v105, v105
    s_add_u32 s52, s4, 2097152
    buffer_store_dwordx4 v[44:47], v1, s[40:43], s52 offen sc1
    v_exp_f32 v106, v106
    v_exp_f32 v107, v107
    v_smfmac_f32_32x32x32_bf16 v[128:143], v[20:23], v[96:103], v36
    v_exp_f32 v108, v108
    v_exp_f32 v109, v109
    v_exp_f32 v110, v110
    v_exp_f32 v111, v111
    ds_read_b128 v[12:15], v37 offset:16384
    v_exp_f32 v80, v80
    v_exp_f32 v81, v81
    v_smfmac_f32_32x32x32_bf16 v[128:143], v[24:27], v[104:111], v36
    v_exp_f32 v82, v82
    v_exp_f32 v83, v83
    v_exp_f32 v84, v84
    v_mfma_f32_32x32x16_bf16 v[96:111], v[16:19], v[8:11], v[64:79]
    s_mov_b64 exec, s[62:63]
    ds_read_b128 v[20:23], v37 offset:17408
    ds_read_b128 v[24:27], v37 offset:17664
    s_mov_b64 exec, -1
    v_exp_f32 v85, v85
    v_exp_f32 v86, v86
    v_exp_f32 v87, v87
    v_exp_f32 v88, v88
    v_exp_f32 v89, v89
    s_cmp_lg_u32 s3, 0
    s_cselect_b32 exec_lo, 0, 0x00ff00ff
    s_mov_b32 exec_hi, 0
    buffer_store_dword v44, v43, s[40:43], s7 offen sc1
    s_mov_b64 exec, -1
    v_exp_f32 v90, v90
    v_exp_f32 v91, v91
    v_smfmac_f32_32x32x32_bf16 v[112:127], v[28:31], v[80:87], v36
    v_exp_f32 v92, v92
    v_exp_f32 v93, v93
    v_exp_f32 v94, v94
    v_exp_f32 v95, v95
    v_exp_f32 v96, v96
    v_exp_f32 v97, v97
    v_smfmac_f32_32x32x32_bf16 v[112:127], v[32:35], v[88:95], v36
    v_exp_f32 v98, v98
    v_exp_f32 v99, v99
    v_exp_f32 v100, v100
    s_waitcnt lgkmcnt(0)
    v_mfma_f32_32x32x16_bf16 v[80:95], v[12:15], v[4:7], v[48:63]
    v_exp_f32 v101, v101
    v_exp_f32 v102, v102
    v_exp_f32 v103, v103
    v_exp_f32 v104, v104
    v_exp_f32 v105, v105
    v_exp_f32 v106, v106
    v_exp_f32 v107, v107
    v_smfmac_f32_32x32x32_bf16 v[128:143], v[28:31], v[96:103], v36
    v_exp_f32 v108, v108
    v_exp_f32 v109, v109
    v_exp_f32 v110, v110
    v_exp_f32 v111, v111
L_slot4:
    s_setprio 1
    ds_read_b128 v[16:19], v37 offset:18432
    v_exp_f32 v80, v80
    v_exp_f32 v81, v81
    v_smfmac_f32_32x32x32_bf16 v[128:143], v[32:35], v[104:111], v36
    v_exp_f32 v82, v82
    v_exp_f32 v83, v83
    v_exp_f32 v84, v84
    v_mfma_f32_32x32x16_bf16 v[96:111], v[12:15], v[8:11], v[64:79]
    s_mov_b64 exec, s[62:63]
    ds_read_b128 v[28:31], v37 offset:19456
    ds_read_b128 v[32:35], v37 offset:19712
    s_mov_b64 exec, -1
    v_exp_f32 v85, v85
    v_exp_f32 v86, v86
    v_exp_f32 v87, v87
    v_exp_f32 v88, v88
    s_add_u32 m0, s66, 36864
    s_add_u32 s56, m0, s67
    v_exp_f32 v89, v89
    v_exp_f32 v90, v90
    v_exp_f32 v91, v91
    v_smfmac_f32_32x32x32_bf16 v[112:127], v[20:23], v[80:87], v36
    v_exp_f32 v92, v92
    v_exp_f32 v93, v93
    v_exp_f32 v94, v94
    v_exp_f32 v95, v95
    v_exp_f32 v96, v96
    v_exp_f32 v97, v97
    buffer_load_dwordx4 v1, s[40:43], s56 offen offset:0 sc1 lds
    v_smfmac_f32_32x32x32_bf16 v[112:127], v[24:27], v[88:95], v36
    v_exp_f32 v98, v98
    v_exp_f32 v99, v99
    v_exp_f32 v100, v100
    s_waitcnt lgkmcnt(0)
    v_mfma_f32_32x32x16_bf16 v[80:95], v[16:19], v[4:7], v[48:63]
    v_exp_f32 v101, v101
    v_exp_f32 v102, v102
    v_exp_f32 v103, v103
    v_exp_f32 v104, v104
    v_exp_f32 v105, v105
    v_exp_f32 v106, v106
    v_exp_f32 v107, v107
    buffer_load_dwordx4 v1, s[40:43], s56 offen offset:1024 sc1 lds
    v_smfmac_f32_32x32x32_bf16 v[128:143], v[20:23], v[96:103], v36
    v_exp_f32 v108, v108
    v_exp_f32 v109, v109
    v_exp_f32 v110, v110
    v_exp_f32 v111, v111
    ds_read_b128 v[12:15], v37 offset:20480
    v_exp_f32 v80, v80
    v_exp_f32 v81, v81
    v_smfmac_f32_32x32x32_bf16 v[128:143], v[24:27], v[104:111], v36
    v_exp_f32 v82, v82
    v_exp_f32 v83, v83
    v_exp_f32 v84, v84
    v_mfma_f32_32x32x16_bf16 v[96:111], v[16:19], v[8:11], v[64:79]
    s_mov_b64 exec, s[62:63]
    ds_read_b128 v[20:23], v37 offset:21504
    ds_read_b128 v[24:27], v37 offset:21760
    s_mov_b64 exec, -1
    v_exp_f32 v85, v85
    buffer_load_dwordx4 v1, s[40:43], s56 offen offset:2048 sc1 lds
    v_exp_f32 v86, v86
    v_exp_f32 v87, v87
    v_exp_f32 v88, v88
    v_exp_f32 v89, v89
    v_exp_f32 v90, v90
    v_exp_f32 v91, v91
    v_smfmac_f32_32x32x32_bf16 v[112:127], v[28:31], v[80:87], v36
    v_exp_f32 v92, v92
    v_exp_f32 v93, v93
    v_exp_f32 v94, v94
    v_exp_f32 v95, v95
    buffer_load_dwordx4 v1, s[40:43], s56 offen offset:3072 sc1 lds
    v_exp_f32 v96, v96
    v_exp_f32 v97, v97
    v_smfmac_f32_32x32x32_bf16 v[112:127], v[32:35], v[88:95], v36
    v_exp_f32 v98, v98
    v_exp_f32 v99, v99
    v_exp_f32 v100, v100
    s_waitcnt lgkmcnt(0)
    v_mfma_f32_32x32x16_bf16 v[80:95], v[12:15], v[4:7], v[48:63]
    v_exp_f32 v101, v101
    v_exp_f32 v102, v102
    v_exp_f32 v103, v103
    v_exp_f32 v104, v104
    v_exp_f32 v105, v105
    v_exp_f32 v106, v106
    v_exp_f32 v107, v107
    v_smfmac_f32_32x32x32_bf16 v[128:143], v[28:31], v[96:103], v36
    v_exp_f32 v108, v108
    v_exp_f32 v109, v109
    v_exp_f32 v110, v110
    v_exp_f32 v111, v111
L_slot5:
    s_setprio 0
    ds_read_b128 v[16:19], v37 offset:22528
    v_exp_f32 v80, v80
    v_exp_f32 v81, v81
    v_smfmac_f32_32x32x32_bf16 v[128:143], v[32:35], v[104:111], v36
    v_exp_f32 v82, v82
    v_exp_f32 v83, v83
    v_exp_f32 v84, v84
    v_mfma_f32_32x32x16_bf16 v[96:111], v[12:15], v[8:11], v[64:79]
    s_mov_b64 exec, s[62:63]
    ds_read_b128 v[28:31], v37 offset:23552
    ds_read_b128 v[32:35], v37 offset:23808
    s_mov_b64 exec, -1
    v_exp_f32 v85, v85
    v_exp_f32 v86, v86
    v_exp_f32 v87, v87
    v_exp_f32 v88, v88
    v_exp_f32 v89, v89
    v_exp_f32 v90, v90
    v_exp_f32 v91, v91
    v_smfmac_f32_32x32x32_bf16 v[112:127], v[20:23], v[80:87], v36
    v_exp_f32 v92, v92
    v_exp_f32 v93, v93
    v_exp_f32 v94, v94
    v_exp_f32 v95, v95
    v_exp_f32 v96, v96
    v_exp_f32 v97, v97
    v_smfmac_f32_32x32x32_bf16 v[112:127], v[24:27], v[88:95], v36
    v_exp_f32 v98, v98
    v_exp_f32 v99, v99
    v_exp_f32 v100, v100
    s_waitcnt lgkmcnt(0)
    v_mfma_f32_32x32x16_bf16 v[80:95], v[16:19], v[4:7], v[48:63]
    v_exp_f32 v101, v101
    v_exp_f32 v102, v102
    v_exp_f32 v103, v103
    v_exp_f32 v104, v104
    v_exp_f32 v105, v105
    v_exp_f32 v106, v106
    v_exp_f32 v107, v107
    v_smfmac_f32_32x32x32_bf16 v[128:143], v[20:23], v[96:103], v36
    v_exp_f32 v108, v108
    v_exp_f32 v109, v109
    v_exp_f32 v110, v110
    v_exp_f32 v111, v111
    ds_read_b128 v[12:15], v37 offset:24576
    v_exp_f32 v80, v80
    v_exp_f32 v81, v81
    v_smfmac_f32_32x32x32_bf16 v[128:143], v[24:27], v[104:111], v36
    v_exp_f32 v82, v82
    v_exp_f32 v83, v83
    v_exp_f32 v84, v84
    v_mfma_f32_32x32x16_bf16 v[96:111], v[16:19], v[8:11], v[64:79]
    s_mov_b64 exec, s[62:63]
    ds_read_b128 v[20:23], v37 offset:25600
    ds_read_b128 v[24:27], v37 offset:25856
    s_mov_b64 exec, -1
    v_exp_f32 v85, v85
    v_exp_f32 v86, v86
    v_exp_f32 v87, v87
    v_exp_f32 v88, v88
    v_exp_f32 v89, v89
    v_exp_f32 v90, v90
    v_exp_f32 v91, v91
    v_smfmac_f32_32x32x32_bf16 v[112:127], v[28:31], v[80:87], v36
    v_exp_f32 v92, v92
    v_exp_f32 v93, v93
    v_exp_f32 v94, v94
    v_exp_f32 v95, v95
    v_exp_f32 v96, v96
    v_exp_f32 v97, v97
    v_smfmac_f32_32x32x32_bf16 v[112:127], v[32:35], v[88:95], v36
    v_exp_f32 v98, v98
    v_exp_f32 v99, v99
    v_exp_f32 v100, v100
    s_waitcnt lgkmcnt(0)
    v_mfma_f32_32x32x16_bf16 v[80:95], v[12:15], v[4:7], v[48:63]
    v_exp_f32 v101, v101
    v_exp_f32 v102, v102
    v_exp_f32 v103, v103
    v_exp_f32 v104, v104
    v_exp_f32 v105, v105
    v_exp_f32 v106, v106
    v_exp_f32 v107, v107
    v_smfmac_f32_32x32x32_bf16 v[128:143], v[28:31], v[96:103], v36
    v_exp_f32 v108, v108
    v_exp_f32 v109, v109
    v_exp_f32 v110, v110
    v_exp_f32 v111, v111
L_slot6:
    s_waitcnt vmcnt(0)
    s_barrier
    s_cmp_lg_u32 s48, 0
    s_cbranch_scc1 L_sig2done
    s_lshl_b32 s52, s49, 8
    s_add_u32 s52, s52, 20054016
    v_mov_b32 v38, 1
    s_mov_b64 exec, 1
    buffer_atomic_add v38, v3, s[40:43], s52 offen sc1
    s_mov_b64 exec, -1
L_sig2done:
    s_setprio 3
    ds_read_b128 v[16:19], v37 offset:26624
    v_exp_f32 v80, v80
    v_exp_f32 v81, v81
    v_smfmac_f32_32x32x32_bf16 v[128:143], v[32:35], v[104:111], v36
    v_exp_f32 v82, v82
    v_exp_f32 v83, v83
    v_exp_f32 v84, v84
    v_mfma_f32_32x32x16_bf16 v[96:111], v[12:15], v[8:11], v[64:79]
    s_mov_b64 exec, s[62:63]
    ds_read_b128 v[28:31], v37 offset:27648
    ds_read_b128 v[32:35], v37 offset:27904
    s_mov_b64 exec, -1
    v_exp_f32 v85, v85
    v_exp_f32 v86, v86
    v_exp_f32 v87, v87
    v_exp_f32 v88, v88
    v_exp_f32 v89, v89
    v_exp_f32 v90, v90
    v_exp_f32 v91, v91
    v_smfmac_f32_32x32x32_bf16 v[112:127], v[20:23], v[80:87], v36
    v_exp_f32 v92, v92
    v_exp_f32 v93, v93
    v_exp_f32 v94, v94
    v_exp_f32 v95, v95
    v_exp_f32 v96, v96
    v_exp_f32 v97, v97
    v_smfmac_f32_32x32x32_bf16 v[112:127], v[24:27], v[88:95], v36
    v_exp_f32 v98, v98
    v_exp_f32 v99, v99
    v_exp_f32 v100, v100
    s_waitcnt lgkmcnt(0)
    v_mfma_f32_32x32x16_bf16 v[80:95], v[16:19], v[4:7], v[48:63]
    v_exp_f32 v101, v101
    v_exp_f32 v102, v102
    v_exp_f32 v103, v103
    v_exp_f32 v104, v104
    v_exp_f32 v105, v105
    v_exp_f32 v106, v106
    v_exp_f32 v107, v107
    v_smfmac_f32_32x32x32_bf16 v[128:143], v[20:23], v[96:103], v36
    v_exp_f32 v108, v108
    v_exp_f32 v109, v109
    v_exp_f32 v110, v110
    v_exp_f32 v111, v111
    ds_read_b128 v[12:15], v37 offset:28672
    v_exp_f32 v80, v80
    v_exp_f32 v81, v81
    v_smfmac_f32_32x32x32_bf16 v[128:143], v[24:27], v[104:111], v36
    v_exp_f32 v82, v82
    v_exp_f32 v83, v83
    v_exp_f32 v84, v84
    v_mfma_f32_32x32x16_bf16 v[96:111], v[16:19], v[8:11], v[64:79]
    s_mov_b64 exec, s[62:63]
    ds_read_b128 v[20:23], v37 offset:29696
    ds_read_b128 v[24:27], v37 offset:29952
    s_mov_b64 exec, -1
    v_exp_f32 v85, v85
    v_exp_f32 v86, v86
    v_exp_f32 v87, v87
    v_exp_f32 v88, v88
    v_exp_f32 v89, v89
    v_exp_f32 v90, v90
    v_exp_f32 v91, v91
    v_smfmac_f32_32x32x32_bf16 v[112:127], v[28:31], v[80:87], v36
    v_exp_f32 v92, v92
    v_exp_f32 v93, v93
    v_exp_f32 v94, v94
    v_exp_f32 v95, v95
    v_exp_f32 v96, v96
    v_exp_f32 v97, v97
    v_smfmac_f32_32x32x32_bf16 v[112:127], v[32:35], v[88:95], v36
    v_exp_f32 v98, v98
    v_exp_f32 v99, v99
    v_exp_f32 v100, v100
    s_waitcnt lgkmcnt(0)
    v_mfma_f32_32x32x16_bf16 v[80:95], v[12:15], v[4:7], v[48:63]
    v_exp_f32 v101, v101
    v_exp_f32 v102, v102
    v_exp_f32 v103, v103
    v_exp_f32 v104, v104
    v_exp_f32 v105, v105
    v_exp_f32 v106, v106
    v_exp_f32 v107, v107
    v_smfmac_f32_32x32x32_bf16 v[128:143], v[28:31], v[96:103], v36
    v_exp_f32 v108, v108
    v_exp_f32 v109, v109
    v_exp_f32 v110, v110
    v_exp_f32 v111, v111
L_slot7:
    s_setprio 3
    ds_read_b128 v[16:19], v37 offset:30720
    v_exp_f32 v80, v80
    v_exp_f32 v81, v81
    v_smfmac_f32_32x32x32_bf16 v[128:143], v[32:35], v[104:111], v36
    v_exp_f32 v82, v82
    v_exp_f32 v83, v83
    v_exp_f32 v84, v84
    v_mfma_f32_32x32x16_bf16 v[96:111], v[12:15], v[8:11], v[64:79]
    s_mov_b64 exec, s[62:63]
    ds_read_b128 v[28:31], v37 offset:31744
    ds_read_b128 v[32:35], v37 offset:32000
    s_mov_b64 exec, -1
    v_exp_f32 v85, v85
    v_exp_f32 v86, v86
    v_exp_f32 v87, v87
    v_exp_f32 v88, v88
    v_exp_f32 v89, v89
    v_exp_f32 v90, v90
    v_exp_f32 v91, v91
    v_smfmac_f32_32x32x32_bf16 v[112:127], v[20:23], v[80:87], v36
    v_exp_f32 v92, v92
    v_exp_f32 v93, v93
    v_exp_f32 v94, v94
    v_exp_f32 v95, v95
    v_exp_f32 v96, v96
    v_exp_f32 v97, v97
    v_smfmac_f32_32x32x32_bf16 v[112:127], v[24:27], v[88:95], v36
    v_exp_f32 v98, v98
    v_exp_f32 v99, v99
    v_exp_f32 v100, v100
    s_waitcnt lgkmcnt(0)
    v_mfma_f32_32x32x16_bf16 v[80:95], v[16:19], v[4:7], v[48:63]
    v_exp_f32 v101, v101
    v_exp_f32 v102, v102
    v_exp_f32 v103, v103
    v_exp_f32 v104, v104
    v_exp_f32 v105, v105
    v_exp_f32 v106, v106
    v_exp_f32 v107, v107
    v_smfmac_f32_32x32x32_bf16 v[128:143], v[20:23], v[96:103], v36
    v_exp_f32 v108, v108
    v_exp_f32 v109, v109
    v_exp_f32 v110, v110
    v_exp_f32 v111, v111
    ds_read_b128 v[12:15], v37 offset:32768
    v_exp_f32 v80, v80
    v_exp_f32 v81, v81
    v_smfmac_f32_32x32x32_bf16 v[128:143], v[24:27], v[104:111], v36
    v_exp_f32 v82, v82
    v_exp_f32 v83, v83
    v_exp_f32 v84, v84
    v_mfma_f32_32x32x16_bf16 v[96:111], v[16:19], v[8:11], v[64:79]
    s_mov_b64 exec, s[62:63]
    ds_read_b128 v[20:23], v37 offset:33792
    ds_read_b128 v[24:27], v37 offset:34048
    s_mov_b64 exec, -1
    v_exp_f32 v85, v85
    v_exp_f32 v86, v86
    v_exp_f32 v87, v87
    v_exp_f32 v88, v88
    v_exp_f32 v89, v89
    v_exp_f32 v90, v90
    v_exp_f32 v91, v91
    v_smfmac_f32_32x32x32_bf16 v[112:127], v[28:31], v[80:87], v36
    v_exp_f32 v92, v92
    v_exp_f32 v93, v93
    v_exp_f32 v94, v94
    v_exp_f32 v95, v95
    v_exp_f32 v96, v96
    v_exp_f32 v97, v97
    v_smfmac_f32_32x32x32_bf16 v[112:127], v[32:35], v[88:95], v36
    v_exp_f32 v98, v98
    v_exp_f32 v99, v99
    v_exp_f32 v100, v100
    s_waitcnt lgkmcnt(0)
    v_mfma_f32_32x32x16_bf16 v[80:95], v[12:15], v[4:7], v[48:63]
    v_exp_f32 v101, v101
    v_exp_f32 v102, v102
    v_exp_f32 v103, v103
    v_exp_f32 v104, v104
    s_cmp_lg_u32 s3, 0
    s_cbranch_scc1 L_skipA
    buffer_load_dword v41, v3, s[40:43], s5 offen sc1
L_skipA:
    v_exp_f32 v105, v105
    v_exp_f32 v106, v106
    v_exp_f32 v107, v107
    v_smfmac_f32_32x32x32_bf16 v[128:143], v[28:31], v[96:103], v36
    v_exp_f32 v108, v108
    v_exp_f32 v109, v109
    v_exp_f32 v110, v110
    v_exp_f32 v111, v111
L_slot8:
    s_setprio 2
    ds_read_b128 v[16:19], v37 offset:34816
    v_exp_f32 v80, v80
    v_exp_f32 v81, v81
    v_smfmac_f32_32x32x32_bf16 v[128:143], v[32:35], v[104:111], v36
    v_exp_f32 v82, v82
    v_exp_f32 v83, v83
    v_exp_f32 v84, v84
    v_mfma_f32_32x32x16_bf16 v[96:111], v[12:15], v[8:11], v[64:79]
    s_mov_b64 exec, s[62:63]
    ds_read_b128 v[28:31], v37 offset:35840
    ds_read_b128 v[32:35], v37 offset:36096
    s_mov_b64 exec, -1
    v_exp_f32 v85, v85
    v_exp_f32 v86, v86
    v_exp_f32 v87, v87
    v_exp_f32 v88, v88
    v_exp_f32 v89, v89
    v_exp_f32 v90, v90
    s_cmp_lg_u32 s3, 0
    s_cbranch_scc1 L_skipB
    s_waitcnt vmcnt(0)
    v_readfirstlane_b32 s58, v41
    s_add_u32 s52, s6, 32768
    s_add_u32 s53, s6, 65536
    s_add_u32 s54, s6, 98304
    s_cmp_lt_u32 s58, 32
    s_cbranch_scc1 L_flagspin
L_flagok:
    buffer_load_dwordx4 v[144:147], v42, s[40:43], s6 offen sc1
    buffer_load_dwordx4 v[148:151], v42, s[40:43], s52 offen sc1
    buffer_load_dwordx4 v[152:155], v42, s[40:43], s53 offen sc1
    buffer_load_dwordx4 v[156:159], v42, s[40:43], s54 offen sc1
L_skipB:
    v_exp_f32 v91, v91
    v_smfmac_f32_32x32x32_bf16 v[112:127], v[20:23], v[80:87], v36
    v_exp_f32 v92, v92
    v_exp_f32 v93, v93
    v_exp_f32 v94, v94
    s_add_u32 m0, s66, 53248
    s_add_u32 s56, m0, s67
    v_exp_f32 v95, v95
    v_exp_f32 v96, v96
    v_exp_f32 v97, v97
    v_smfmac_f32_32x32x32_bf16 v[112:127], v[24:27], v[88:95], v36
    v_exp_f32 v98, v98
    v_exp_f32 v99, v99
    buffer_load_dwordx4 v1, s[40:43], s56 offen offset:0 sc1 lds
    v_exp_f32 v100, v100
    s_waitcnt lgkmcnt(0)
    v_mfma_f32_32x32x16_bf16 v[80:95], v[16:19], v[4:7], v[48:63]
    v_exp_f32 v101, v101
    v_exp_f32 v102, v102
    v_exp_f32 v103, v103
    v_exp_f32 v104, v104
    buffer_load_dwordx4 v1, s[40:43], s56 offen offset:1024 sc1 lds
    v_exp_f32 v105, v105
    v_exp_f32 v106, v106
    v_exp_f32 v107, v107
    v_smfmac_f32_32x32x32_bf16 v[128:143], v[20:23], v[96:103], v36
    v_exp_f32 v108, v108
    v_exp_f32 v109, v109
    buffer_load_dwordx4 v1, s[40:43], s56 offen offset:2048 sc1 lds
    v_exp_f32 v110, v110
    v_exp_f32 v111, v111
    ds_read_b128 v[12:15], v37 offset:36864
    v_exp_f32 v80, v80
    v_exp_f32 v81, v81
    v_smfmac_f32_32x32x32_bf16 v[128:143], v[24:27], v[104:111], v36
    v_exp_f32 v82, v82
    buffer_load_dwordx4 v1, s[40:43], s56 offen offset:3072 sc1 lds
    v_exp_f32 v83, v83
    v_exp_f32 v84, v84
    v_mfma_f32_32x32x16_bf16 v[96:111], v[16:19], v[8:11], v[64:79]
    s_mov_b64 exec, s[62:63]
    ds_read_b128 v[20:23], v37 offset:37888
    ds_read_b128 v[24:27], v37 offset:38144
    s_mov_b64 exec, -1
    v_exp_f32 v85, v85
    v_exp_f32 v86, v86
    v_exp_f32 v87, v87
    v_exp_f32 v88, v88
    v_exp_f32 v89, v89
    v_exp_f32 v90, v90
    v_exp_f32 v91, v91
    v_smfmac_f32_32x32x32_bf16 v[112:127], v[28:31], v[80:87], v36
    v_exp_f32 v92, v92
    v_exp_f32 v93, v93
    v_exp_f32 v94, v94
    v_exp_f32 v95, v95
    v_exp_f32 v96, v96
    v_exp_f32 v97, v97
    v_smfmac_f32_32x32x32_bf16 v[112:127], v[32:35], v[88:95], v36
    v_exp_f32 v98, v98
    v_exp_f32 v99, v99
    v_exp_f32 v100, v100
    s_waitcnt lgkmcnt(0)
    v_mfma_f32_32x32x16_bf16 v[80:95], v[12:15], v[4:7], v[48:63]
    v_exp_f32 v101, v101
    v_exp_f32 v102, v102
    v_exp_f32 v103, v103
    v_exp_f32 v104, v104
    v_exp_f32 v105, v105
    v_exp_f32 v106, v106
    v_exp_f32 v107, v107
    v_smfmac_f32_32x32x32_bf16 v[128:143], v[28:31], v[96:103], v36
    v_exp_f32 v108, v108
    v_exp_f32 v109, v109
    v_exp_f32 v110, v110
    v_exp_f32 v111, v111
L_slot9:
    s_setprio 2
    v_add_u32 v37, 36864, v37
    ds_read_b128 v[16:19], v37 offset:2048
    v_exp_f32 v80, v80
    v_exp_f32 v81, v81
    v_smfmac_f32_32x32x32_bf16 v[128:143], v[32:35], v[104:111], v36
    v_exp_f32 v82, v82
    v_exp_f32 v83, v83
    v_exp_f32 v84, v84
    v_mfma_f32_32x32x16_bf16 v[96:111], v[12:15], v[8:11], v[64:79]
    s_mov_b64 exec, s[62:63]
    ds_read_b128 v[28:31], v37 offset:3072
    ds_read_b128 v[32:35], v37 offset:3328
    s_mov_b64 exec, -1
    v_exp_f32 v85, v85
    v_exp_f32 v86, v86
    v_exp_f32 v87, v87
    v_exp_f32 v88, v88
    v_exp_f32 v89, v89
    v_exp_f32 v90, v90
    v_exp_f32 v91, v91
    v_smfmac_f32_32x32x32_bf16 v[112:127], v[20:23], v[80:87], v36
    v_exp_f32 v92, v92
    v_exp_f32 v93, v93
    v_exp_f32 v94, v94
    v_exp_f32 v95, v95
    v_exp_f32 v96, v96
    v_exp_f32 v97, v97
    v_smfmac_f32_32x32x32_bf16 v[112:127], v[24:27], v[88:95], v36
    v_exp_f32 v98, v98
    v_exp_f32 v99, v99
    v_exp_f32 v100, v100
    s_waitcnt lgkmcnt(0)
    v_mfma_f32_32x32x16_bf16 v[80:95], v[16:19], v[4:7], v[48:63]
    v_exp_f32 v101, v101
    v_exp_f32 v102, v102
    v_exp_f32 v103, v103
    v_exp_f32 v104, v104
    v_exp_f32 v105, v105
    v_exp_f32 v106, v106
    v_exp_f32 v107, v107
    v_smfmac_f32_32x32x32_bf16 v[128:143], v[20:23], v[96:103], v36
    v_exp_f32 v108, v108
    v_exp_f32 v109, v109
    v_exp_f32 v110, v110
    s_waitcnt vmcnt(0)
    s_cmp_lg_u32 s3, 0
    s_cbranch_scc1 L_skipC
    v_add_f32 v144, v144, v148
    v_add_f32 v145, v145, v149
    v_add_f32 v146, v146, v150
    v_add_f32 v147, v147, v151
    v_add_f32 v152, v152, v156
    v_add_f32 v153, v153, v157
    v_add_f32 v154, v154, v158
    v_add_f32 v155, v155, v159
    v_add_f32 v144, v144, v152
    v_add_f32 v145, v145, v153
    v_add_f32 v146, v146, v154
    v_add_f32 v147, v147, v155
    v_permlane32_swap_b32 v144, v145
    s_nop 0
    v_permlane32_swap_b32 v146, v147
    v_add_f32 v144, v144, v145
    s_nop 0
    v_add_f32 v146, v146, v147
    s_nop 1
    v_permlane16_swap_b32 v144, v146
    s_nop 1
    v_add_f32 v144, v144, v146
    s_nop 1
    v_add_f32_dpp v144, v144, v144 row_ror:8 row_mask:0xf bank_mask:0xf
    v_mov_b32 v145, v144
    s_nop 1
    v_permlane32_swap_b32 v144, v145
    s_nop 1
    v_cvt_pk_bf16_f32 v40, v144, v145
    v_min_u32 v40, -2, v40
    s_mov_b32 exec_lo, 0x00ff00ff
    s_mov_b32 exec_hi, 0
    buffer_store_dword v40, v43, s[40:43], s7 offen sc1
    s_mov_b64 exec, -1
L_skipC:
    v_exp_f32 v111, v111
    ds_read_b128 v[12:15], v37 offset:4096
    v_exp_f32 v80, v80
    v_exp_f32 v81, v81
    v_smfmac_f32_32x32x32_bf16 v[128:143], v[24:27], v[104:111], v36
    v_exp_f32 v82, v82
    v_exp_f32 v83, v83
    v_exp_f32 v84, v84
    v_mfma_f32_32x32x16_bf16 v[96:111], v[16:19], v[8:11], v[64:79]
    s_mov_b64 exec, s[62:63]
    ds_read_b128 v[20:23], v37 offset:5120
    ds_read_b128 v[24:27], v37 offset:5376
    s_mov_b64 exec, -1
    v_exp_f32 v85, v85
    v_exp_f32 v86, v86
    v_exp_f32 v87, v87
    v_exp_f32 v88, v88
    v_exp_f32 v89, v89
    v_exp_f32 v90, v90
    v_exp_f32 v91, v91
    v_smfmac_f32_32x32x32_bf16 v[112:127], v[28:31], v[80:87], v36
    v_exp_f32 v92, v92
    v_exp_f32 v93, v93
    v_exp_f32 v94, v94
    v_exp_f32 v95, v95
    v_exp_f32 v96, v96
    v_exp_f32 v97, v97
    v_smfmac_f32_32x32x32_bf16 v[112:127], v[32:35], v[88:95], v36
    v_exp_f32 v98, v98
    v_exp_f32 v99, v99
    v_exp_f32 v100, v100
    s_waitcnt lgkmcnt(0)
    v_mfma_f32_32x32x16_bf16 v[80:95], v[12:15], v[4:7], v[48:63]
    v_exp_f32 v101, v101
    v_exp_f32 v102, v102
    v_exp_f32 v103, v103
    v_exp_f32 v104, v104
    v_exp_f32 v105, v105
    v_exp_f32 v106, v106
    v_exp_f32 v107, v107
    v_smfmac_f32_32x32x32_bf16 v[128:143], v[28:31], v[96:103], v36
    v_exp_f32 v108, v108
    v_exp_f32 v109, v109
    v_exp_f32 v110, v110
    v_exp_f32 v111, v111
L_slot10:
    s_setprio 1
    ds_read_b128 v[16:19], v37 offset:6144
    v_exp_f32 v80, v80
    v_exp_f32 v81, v81
    v_smfmac_f32_32x32x32_bf16 v[128:143], v[32:35], v[104:111], v36
    v_exp_f32 v82, v82
    v_exp_f32 v83, v83
    v_exp_f32 v84, v84
    v_mfma_f32_32x32x16_bf16 v[96:111], v[12:15], v[8:11], v[64:79]
    s_mov_b64 exec, s[62:63]
    ds_read_b128 v[28:31], v37 offset:7168
    ds_read_b128 v[32:35], v37 offset:7424
    s_mov_b64 exec, -1
    v_exp_f32 v85, v85
    v_exp_f32 v86, v86
    v_exp_f32 v87, v87
    v_exp_f32 v88, v88
    v_exp_f32 v89, v89
    v_exp_f32 v90, v90
    v_exp_f32 v91, v91
    v_smfmac_f32_32x32x32_bf16 v[112:127], v[20:23], v[80:87], v36
    v_exp_f32 v92, v92
    v_exp_f32 v93, v93
    v_exp_f32 v94, v94
    v_exp_f32 v95, v95
    v_exp_f32 v96, v96
    v_exp_f32 v97, v97
    v_smfmac_f32_32x32x32_bf16 v[112:127], v[24:27], v[88:95], v36
    v_exp_f32 v98, v98
    v_exp_f32 v99, v99
    v_exp_f32 v100, v100
    s_waitcnt lgkmcnt(0)
    v_mfma_f32_32x32x16_bf16 v[80:95], v[16:19], v[4:7], v[48:63]
    v_exp_f32 v101, v101
    v_exp_f32 v102, v102
    v_exp_f32 v103, v103
    v_exp_f32 v104, v104
    v_exp_f32 v105, v105
    v_exp_f32 v106, v106
    v_exp_f32 v107, v107
    v_smfmac_f32_32x32x32_bf16 v[128:143], v[20:23], v[96:103], v36
    v_exp_f32 v108, v108
    v_exp_f32 v109, v109
    v_exp_f32 v110, v110
    v_exp_f32 v111, v111
    ds_read_b128 v[12:15], v37 offset:8192
    v_exp_f32 v80, v80
    v_exp_f32 v81, v81
    v_smfmac_f32_32x32x32_bf16 v[128:143], v[24:27], v[104:111], v36
    v_exp_f32 v82, v82
    v_exp_f32 v83, v83
    v_exp_f32 v84, v84
    v_mfma_f32_32x32x16_bf16 v[96:111], v[16:19], v[8:11], v[64:79]
    s_mov_b64 exec, s[62:63]
    ds_read_b128 v[20:23], v37 offset:9216
    ds_read_b128 v[24:27], v37 offset:9472
    s_mov_b64 exec, -1
    v_exp_f32 v85, v85
    v_exp_f32 v86, v86
    v_exp_f32 v87, v87
    v_exp_f32 v88, v88
    v_and_b32 v42, 7, v0
    v_exp_f32 v89, v89
    v_exp_f32 v90, v90
    v_exp_f32 v91, v91
    v_smfmac_f32_32x32x32_bf16 v[112:127], v[28:31], v[80:87], v36
    v_exp_f32 v92, v92
    v_lshlrev_b32 v42, 8, v42
    v_exp_f32 v93, v93
    v_exp_f32 v94, v94
    v_exp_f32 v95, v95
    v_exp_f32 v96, v96
    s_mov_b32 s57, 20054016
    v_exp_f32 v97, v97
    v_smfmac_f32_32x32x32_bf16 v[112:127], v[32:35], v[88:95], v36
    v_exp_f32 v98, v98
    v_exp_f32 v99, v99
    v_exp_f32 v100, v100
    buffer_load_dword v41, v42, s[40:43], s57 offen sc1
    s_waitcnt lgkmcnt(0)
    v_mfma_f32_32x32x16_bf16 v[80:95], v[12:15], v[4:7], v[48:63]
    v_exp_f32 v101, v101
    v_exp_f32 v102, v102
    v_exp_f32 v103, v103
    v_exp_f32 v104, v104
    v_exp_f32 v105, v105
    v_exp_f32 v106, v106
    v_exp_f32 v107, v107
    v_smfmac_f32_32x32x32_bf16 v[128:143], v[28:31], v[96:103], v36
    v_exp_f32 v108, v108
    v_exp_f32 v109, v109
    v_exp_f32 v110, v110
    v_exp_f32 v111, v111
L_slot11:
    s_setprio 0
    ds_read_b128 v[16:19], v37 offset:10240
    v_exp_f32 v80, v80
    v_exp_f32 v81, v81
    v_smfmac_f32_32x32x32_bf16 v[128:143], v[32:35], v[104:111], v36
    v_exp_f32 v82, v82
    v_exp_f32 v83, v83
    v_exp_f32 v84, v84
    v_mfma_f32_32x32x16_bf16 v[96:111], v[12:15], v[8:11], v[64:79]
    s_mov_b64 exec, s[62:63]
    ds_read_b128 v[28:31], v37 offset:11264
    ds_read_b128 v[32:35], v37 offset:11520
    s_mov_b64 exec, -1
    v_exp_f32 v85, v85
    v_exp_f32 v86, v86
    v_exp_f32 v87, v87
    v_exp_f32 v88, v88
    v_exp_f32 v89, v89
    v_exp_f32 v90, v90
    v_exp_f32 v91, v91
    v_smfmac_f32_32x32x32_bf16 v[112:127], v[20:23], v[80:87], v36
    v_exp_f32 v92, v92
    v_exp_f32 v93, v93
    v_exp_f32 v94, v94
    v_exp_f32 v95, v95
    v_exp_f32 v96, v96
    v_exp_f32 v97, v97
    v_smfmac_f32_32x32x32_bf16 v[112:127], v[24:27], v[88:95], v36
    v_exp_f32 v98, v98
    v_exp_f32 v99, v99
    v_exp_f32 v100, v100
    s_waitcnt lgkmcnt(0)
    v_mfma_f32_32x32x16_bf16 v[80:95], v[16:19], v[4:7], v[48:63]
    v_exp_f32 v101, v101
    v_exp_f32 v102, v102
    v_exp_f32 v103, v103
    v_exp_f32 v104, v104
    s_waitcnt vmcnt(0)
    v_cmp_gt_u32 vcc, 32, v41
    v_exp_f32 v105, v105
    v_exp_f32 v106, v106
    v_exp_f32 v107, v107
    v_smfmac_f32_32x32x32_bf16 v[128:143], v[20:23], v[96:103], v36
    v_exp_f32 v108, v108
    s_cbranch_vccnz L_flag2spin
L_flag2ok:
    v_exp_f32 v109, v109
    v_exp_f32 v110, v110
    v_exp_f32 v111, v111
    ds_read_b128 v[12:15], v37 offset:12288
    v_exp_f32 v80, v80
    v_exp_f32 v81, v81
    v_smfmac_f32_32x32x32_bf16 v[128:143], v[24:27], v[104:111], v36
    v_exp_f32 v82, v82
    buffer_load_dwordx4 v[244:247], v1, s[40:43], s8 offen sc1
    v_exp_f32 v83, v83
    v_exp_f32 v84, v84
    v_mfma_f32_32x32x16_bf16 v[96:111], v[16:19], v[8:11], v[64:79]
    s_mov_b64 exec, s[62:63]
    ds_read_b128 v[20:23], v37 offset:13312
    ds_read_b128 v[24:27], v37 offset:13568
    s_mov_b64 exec, -1
    v_exp_f32 v85, v85
    v_exp_f32 v86, v86
    v_exp_f32 v87, v87
    v_exp_f32 v88, v88
    v_exp_f32 v89, v89
    buffer_load_dwordx4 v[248:251], v1, s[40:43], s8 offen offset:1024 sc1
    v_exp_f32 v90, v90
    v_exp_f32 v91, v91
    v_smfmac_f32_32x32x32_bf16 v[112:127], v[28:31], v[80:87], v36
    v_exp_f32 v92, v92
    v_exp_f32 v93, v93
    v_exp_f32 v94, v94
    v_exp_f32 v95, v95
    buffer_load_dwordx4 v[208:211], v1, s[40:43], s7 offen sc1
    v_exp_f32 v96, v96
    v_exp_f32 v97, v97
    v_smfmac_f32_32x32x32_bf16 v[112:127], v[32:35], v[88:95], v36
    v_exp_f32 v98, v98
    v_exp_f32 v99, v99
    v_exp_f32 v100, v100
    s_waitcnt lgkmcnt(0)
    v_mfma_f32_32x32x16_bf16 v[80:95], v[12:15], v[4:7], v[48:63]
    v_exp_f32 v101, v101
    v_exp_f32 v102, v102
    buffer_load_dwordx4 v[212:215], v1, s[40:43], s7 offen offset:1024 sc1
    v_exp_f32 v103, v103
    v_exp_f32 v104, v104
    v_exp_f32 v105, v105
    v_exp_f32 v106, v106
    v_exp_f32 v107, v107
    v_smfmac_f32_32x32x32_bf16 v[128:143], v[28:31], v[96:103], v36
    v_exp_f32 v108, v108
    v_exp_f32 v109, v109
    v_exp_f32 v110, v110
    v_exp_f32 v111, v111
L_slot12:
    s_barrier
    s_setprio 3
    ds_read_b128 v[16:19], v37 offset:14336
    v_exp_f32 v80, v80
    v_exp_f32 v81, v81
    v_smfmac_f32_32x32x32_bf16 v[128:143], v[32:35], v[104:111], v36
    v_exp_f32 v82, v82
    v_exp_f32 v83, v83
    v_exp_f32 v84, v84
    v_mfma_f32_32x32x16_bf16 v[96:111], v[12:15], v[8:11], v[64:79]
    s_mov_b64 exec, s[62:63]
    ds_read_b128 v[28:31], v37 offset:15360
    ds_read_b128 v[32:35], v37 offset:15616
    s_mov_b64 exec, -1
    v_exp_f32 v85, v85
    v_exp_f32 v86, v86
    v_exp_f32 v87, v87
    v_exp_f32 v88, v88
    v_exp_f32 v89, v89
    v_exp_f32 v90, v90
    v_exp_f32 v91, v91
    v_smfmac_f32_32x32x32_bf16 v[112:127], v[20:23], v[80:87], v36
    v_exp_f32 v92, v92
    v_exp_f32 v93, v93
    v_exp_f32 v94, v94
    v_exp_f32 v95, v95
    v_exp_f32 v96, v96
    v_exp_f32 v97, v97
    v_smfmac_f32_32x32x32_bf16 v[112:127], v[24:27], v[88:95], v36
    v_exp_f32 v98, v98
    v_exp_f32 v99, v99
    v_exp_f32 v100, v100
    s_waitcnt lgkmcnt(0)
    v_mfma_f32_32x32x16_bf16 v[80:95], v[16:19], v[4:7], v[48:63]
    v_exp_f32 v101, v101
    v_exp_f32 v102, v102
    s_waitcnt vmcnt(0)
    v_max3_u32 v40, v208, v209, v210
    v_exp_f32 v103, v103
    v_max3_u32 v41, v211, v212, v213
    v_exp_f32 v104, v104
    v_max3_u32 v40, v40, v214, v215
    v_exp_f32 v105, v105
    v_max_u32 v40, v40, v41
    v_exp_f32 v106, v106
    v_cmp_eq_u32 vcc, -1, v40
    v_exp_f32 v107, v107
    v_smfmac_f32_32x32x32_bf16 v[128:143], v[20:23], v[96:103], v36
    v_exp_f32 v108, v108
    v_exp_f32 v109, v109
    v_exp_f32 v110, v110
    s_cbranch_vccnz L_ktspin
L_ktok:
    v_mfma_f32_32x32x16_bf16 v[224:239], v[208:211], v[244:247], 0
    v_exp_f32 v111, v111
    ds_read_b128 v[12:15], v37 offset:16384
    v_exp_f32 v80, v80
    v_exp_f32 v81, v81
    v_smfmac_f32_32x32x32_bf16 v[128:143], v[24:27], v[104:111], v36
    v_exp_f32 v82, v82
    v_exp_f32 v83, v83
    v_exp_f32 v84, v84
    v_mfma_f32_32x32x16_bf16 v[96:111], v[16:19], v[8:11], v[64:79]
    s_mov_b64 exec, s[62:63]
    ds_read_b128 v[20:23], v37 offset:17408
    ds_read_b128 v[24:27], v37 offset:17664
    s_mov_b64 exec, -1
    v_exp_f32 v85, v85
    v_exp_f32 v86, v86
    v_exp_f32 v87, v87
    v_exp_f32 v88, v88
    v_exp_f32 v89, v89
    v_exp_f32 v90, v90
    v_exp_f32 v91, v91
    v_smfmac_f32_32x32x32_bf16 v[112:127], v[28:31], v[80:87], v36
    v_exp_f32 v92, v92
    v_exp_f32 v93, v93
    v_mfma_f32_32x32x16_bf16 v[224:239], v[212:215], v[248:251], v[224:239]
    v_exp_f32 v94, v94
    v_exp_f32 v95, v95
    v_exp_f32 v96, v96
    v_exp_f32 v97, v97
    v_smfmac_f32_32x32x32_bf16 v[112:127], v[32:35], v[88:95], v36
    v_exp_f32 v98, v98
    v_exp_f32 v99, v99
    v_exp_f32 v100, v100
    s_waitcnt lgkmcnt(0)
    v_mfma_f32_32x32x16_bf16 v[80:95], v[12:15], v[4:7], v[48:63]
    v_exp_f32 v101, v101
    v_exp_f32 v102, v102
    v_exp_f32 v103, v103
    v_exp_f32 v104, v104
    v_exp_f32 v105, v105
    v_exp_f32 v106, v106
    v_exp_f32 v107, v107
    v_smfmac_f32_32x32x32_bf16 v[128:143], v[28:31], v[96:103], v36
    v_exp_f32 v108, v108
    v_exp_f32 v109, v109
    v_exp_f32 v110, v110
    buffer_load_dwordx4 v[144:147], v1, s[40:43], s10 offen offset:0 sc1
    v_exp_f32 v111, v111
    buffer_load_dwordx4 v[148:151], v1, s[40:43], s10 offen offset:1024 sc1
L_slot13:
    s_setprio 3
    ds_read_b128 v[16:19], v37 offset:18432
    v_exp_f32 v80, v80
    v_add_f32 v40, 0x358637bd, v232
    v_exp_f32 v81, v81
    v_rcp_f32 v40, v40
    v_smfmac_f32_32x32x32_bf16 v[128:143], v[32:35], v[104:111], v36
    v_exp_f32 v82, v82
    v_mul_f32 v224, v224, v40
    v_exp_f32 v83, v83
    v_mul_f32 v225, v225, v40
    v_exp_f32 v84, v84
    v_mfma_f32_32x32x16_bf16 v[96:111], v[12:15], v[8:11], v[64:79]
    s_mov_b64 exec, s[62:63]
    ds_read_b128 v[28:31], v37 offset:19456
    ds_read_b128 v[32:35], v37 offset:19712
    s_mov_b64 exec, -1
    v_exp_f32 v85, v85
    v_mul_f32 v226, v226, v40
    v_exp_f32 v86, v86
    v_mul_f32 v227, v227, v40
    v_exp_f32 v87, v87
    v_mul_f32 v228, v228, v40
    v_exp_f32 v88, v88
    v_exp_f32 v89, v89
    v_mul_f32 v229, v229, v40
    v_exp_f32 v90, v90
    v_mul_f32 v230, v230, v40
    v_exp_f32 v91, v91
    v_mul_f32 v231, v231, v40
    v_smfmac_f32_32x32x32_bf16 v[112:127], v[20:23], v[80:87], v36
    v_exp_f32 v92, v92
    v_exp_f32 v93, v93
    v_cvt_pk_bf16_f32 v240, v224, v225
    v_exp_f32 v94, v94
    v_cvt_pk_bf16_f32 v241, v226, v227
    v_exp_f32 v95, v95
    v_cvt_pk_bf16_f32 v242, v228, v229
    v_exp_f32 v96, v96
    v_exp_f32 v97, v97
    v_cvt_pk_bf16_f32 v243, v230, v231
    v_smfmac_f32_32x32x32_bf16 v[112:127], v[24:27], v[88:95], v36
    v_exp_f32 v98, v98
    v_min_u32 v240, -2, v240
    v_exp_f32 v99, v99
    v_min_u32 v241, -2, v241
    v_exp_f32 v100, v100
    s_waitcnt lgkmcnt(0)
    v_mfma_f32_32x32x16_bf16 v[80:95], v[16:19], v[4:7], v[48:63]
    v_exp_f32 v101, v101
    v_min_u32 v242, -2, v242
    v_exp_f32 v102, v102
    v_min_u32 v243, -2, v243
    v_exp_f32 v103, v103
    s_add_u32 s52, s4, 2097152
    buffer_store_dwordx4 v[240:243], v1, s[40:43], s52 offen sc1
    v_exp_f32 v104, v104
    v_exp_f32 v105, v105
    v_exp_f32 v106, v106
    v_exp_f32 v107, v107
    v_smfmac_f32_32x32x32_bf16 v[128:143], v[20:23], v[96:103], v36
    v_exp_f32 v108, v108
    buffer_load_dwordx4 v[152:155], v1, s[40:43], s10 offen offset:2048 sc1
    v_exp_f32 v109, v109
    v_exp_f32 v110, v110
    v_exp_f32 v111, v111
    ds_read_b128 v[12:15], v37 offset:20480
    v_exp_f32 v80, v80
    v_exp_f32 v81, v81
    v_smfmac_f32_32x32x32_bf16 v[128:143], v[24:27], v[104:111], v36
    v_exp_f32 v82, v82
    buffer_load_dwordx4 v[156:159], v1, s[40:43], s10 offen offset:3072 sc1
    s_add_u32 s10, s10, 4096
    v_exp_f32 v83, v83
    v_exp_f32 v84, v84
    v_mfma_f32_32x32x16_bf16 v[96:111], v[16:19], v[8:11], v[64:79]
    s_mov_b64 exec, s[62:63]
    ds_read_b128 v[20:23], v37 offset:21504
    ds_read_b128 v[24:27], v37 offset:21760
    s_mov_b64 exec, -1
    v_exp_f32 v85, v85
    v_exp_f32 v86, v86
    v_exp_f32 v87, v87
    v_exp_f32 v88, v88
    v_exp_f32 v89, v89
    buffer_load_dwordx4 v[160:163], v1, s[40:43], s10 offen offset:0 sc1
    v_exp_f32 v90, v90
    v_exp_f32 v91, v91
    v_smfmac_f32_32x32x32_bf16 v[112:127], v[28:31], v[80:87], v36
    v_exp_f32 v92, v92
    v_exp_f32 v93, v93
    v_exp_f32 v94, v94
    v_exp_f32 v95, v95
    buffer_load_dwordx4 v[164:167], v1, s[40:43], s10 offen offset:1024 sc1
    v_exp_f32 v96, v96
    v_exp_f32 v97, v97
    v_smfmac_f32_32x32x32_bf16 v[112:127], v[32:35], v[88:95], v36
    v_exp_f32 v98, v98
    v_exp_f32 v99, v99
    v_exp_f32 v100, v100
    s_waitcnt lgkmcnt(0)
    v_mfma_f32_32x32x16_bf16 v[80:95], v[12:15], v[4:7], v[48:63]
    v_exp_f32 v101, v101
    v_exp_f32 v102, v102
    buffer_load_dwordx4 v[168:171], v1, s[40:43], s10 offen offset:2048 sc1
    v_exp_f32 v103, v103
    v_exp_f32 v104, v104
    v_exp_f32 v105, v105
    v_exp_f32 v106, v106
    v_exp_f32 v107, v107
    v_smfmac_f32_32x32x32_bf16 v[128:143], v[28:31], v[96:103], v36
    v_exp_f32 v108, v108
    v_exp_f32 v109, v109
    v_exp_f32 v110, v110
    v_exp_f32 v111, v111
L_slot14:
    s_setprio 2
    ds_read_b128 v[16:19], v37 offset:22528
    v_exp_f32 v80, v80
    v_exp_f32 v81, v81
    v_smfmac_f32_32x32x32_bf16 v[128:143], v[32:35], v[104:111], v36
    v_exp_f32 v82, v82
    buffer_load_dwordx4 v[172:175], v1, s[40:43], s10 offen offset:3072 sc1
    s_add_u32 s10, s10, 4096
    v_exp_f32 v83, v83
    v_exp_f32 v84, v84
    v_mfma_f32_32x32x16_bf16 v[96:111], v[12:15], v[8:11], v[64:79]
    s_mov_b64 exec, s[62:63]
    ds_read_b128 v[28:31], v37 offset:23552
    ds_read_b128 v[32:35], v37 offset:23808
    s_mov_b64 exec, -1
    v_exp_f32 v85, v85
    v_exp_f32 v86, v86
    v_exp_f32 v87, v87
    v_exp_f32 v88, v88
    buffer_load_dwordx4 v[176:179], v1, s[40:43], s10 offen offset:0 sc1
    v_exp_f32 v89, v89
    v_exp_f32 v90, v90
    v_exp_f32 v91, v91
    v_smfmac_f32_32x32x32_bf16 v[112:127], v[20:23], v[80:87], v36
    v_exp_f32 v92, v92
    v_exp_f32 v93, v93
    v_exp_f32 v94, v94
    v_exp_f32 v95, v95
    buffer_load_dwordx4 v[180:183], v1, s[40:43], s10 offen offset:1024 sc1
    v_exp_f32 v96, v96
    v_exp_f32 v97, v97
    v_smfmac_f32_32x32x32_bf16 v[112:127], v[24:27], v[88:95], v36
    v_exp_f32 v98, v98
    v_exp_f32 v99, v99
    v_exp_f32 v100, v100
    s_waitcnt lgkmcnt(0)
    v_mfma_f32_32x32x16_bf16 v[80:95], v[16:19], v[4:7], v[48:63]
    v_exp_f32 v101, v101
    buffer_load_dwordx4 v[184:187], v1, s[40:43], s10 offen offset:2048 sc1
    v_exp_f32 v102, v102
    v_exp_f32 v103, v103
    v_exp_f32 v104, v104
    v_exp_f32 v105, v105
    v_exp_f32 v106, v106
    v_exp_f32 v107, v107
    v_smfmac_f32_32x32x32_bf16 v[128:143], v[20:23], v[96:103], v36
    v_exp_f32 v108, v108
    buffer_load_dwordx4 v[188:191], v1, s[40:43], s10 offen offset:3072 sc1
    s_add_u32 s10, s10, 4096
    v_exp_f32 v109, v109
    v_exp_f32 v110, v110
    v_exp_f32 v111, v111
    ds_read_b128 v[12:15], v37 offset:24576
    v_exp_f32 v80, v80
    v_exp_f32 v81, v81
    v_smfmac_f32_32x32x32_bf16 v[128:143], v[24:27], v[104:111], v36
    v_exp_f32 v82, v82
    buffer_load_dwordx4 v[192:195], v1, s[40:43], s10 offen offset:0 sc1
    v_exp_f32 v83, v83
    v_exp_f32 v84, v84
    v_mfma_f32_32x32x16_bf16 v[96:111], v[16:19], v[8:11], v[64:79]
    s_mov_b64 exec, s[62:63]
    ds_read_b128 v[20:23], v37 offset:25600
    ds_read_b128 v[24:27], v37 offset:25856
    s_mov_b64 exec, -1
    v_exp_f32 v85, v85
    v_exp_f32 v86, v86
    v_exp_f32 v87, v87
    v_exp_f32 v88, v88
    v_exp_f32 v89, v89
    buffer_load_dwordx4 v[196:199], v1, s[40:43], s10 offen offset:1024 sc1
    v_exp_f32 v90, v90
    v_exp_f32 v91, v91
    v_smfmac_f32_32x32x32_bf16 v[112:127], v[28:31], v[80:87], v36
    v_exp_f32 v92, v92
    v_exp_f32 v93, v93
    v_exp_f32 v94, v94
    v_exp_f32 v95, v95
    buffer_load_dwordx4 v[200:203], v1, s[40:43], s10 offen offset:2048 sc1
    v_exp_f32 v96, v96
    v_exp_f32 v97, v97
    v_smfmac_f32_32x32x32_bf16 v[112:127], v[32:35], v[88:95], v36
    v_exp_f32 v98, v98
    v_exp_f32 v99, v99
    v_exp_f32 v100, v100
    s_waitcnt lgkmcnt(0)
    v_mfma_f32_32x32x16_bf16 v[80:95], v[12:15], v[4:7], v[48:63]
    v_exp_f32 v101, v101
    v_exp_f32 v102, v102
    buffer_load_dwordx4 v[204:207], v1, s[40:43], s10 offen offset:3072 sc1
    s_add_u32 s10, s10, 4096
    v_exp_f32 v103, v103
    v_exp_f32 v104, v104
    v_exp_f32 v105, v105
    v_exp_f32 v106, v106
    v_exp_f32 v107, v107
    v_smfmac_f32_32x32x32_bf16 v[128:143], v[28:31], v[96:103], v36
    v_exp_f32 v108, v108
    v_exp_f32 v109, v109
    v_exp_f32 v110, v110
    v_exp_f32 v111, v111
L_slot15:
    s_setprio 1
    ds_read_b128 v[16:19], v37 offset:26624
    v_exp_f32 v80, v80
    v_exp_f32 v81, v81
    v_smfmac_f32_32x32x32_bf16 v[128:143], v[32:35], v[104:111], v36
    v_exp_f32 v82, v82
    s_add_u32 m0, s1, 0
    s_add_u32 s53, s9, 0
    v_exp_f32 v83, v83
    v_exp_f32 v84, v84
    v_mfma_f32_32x32x16_bf16 v[96:111], v[12:15], v[8:11], v[64:79]
    s_mov_b64 exec, s[62:63]
    ds_read_b128 v[28:31], v37 offset:27648
    ds_read_b128 v[32:35], v37 offset:27904
    s_mov_b64 exec, -1
    v_exp_f32 v85, v85
    s_and_b32 s54, s48, 3
    v_exp_f32 v86, v86
    v_exp_f32 v87, v87
    buffer_load_dwordx4 v1, s[40:43], s53 offen offset:0 sc1 lds
    v_exp_f32 v88, v88
    v_exp_f32 v89, v89
    v_exp_f32 v90, v90
    s_mul_i32 s55, s54, 4608
    v_exp_f32 v91, v91
    v_smfmac_f32_32x32x32_bf16 v[112:127], v[20:23], v[80:87], v36
    v_exp_f32 v92, v92
    v_exp_f32 v93, v93
    buffer_load_dwordx4 v1, s[40:43], s53 offen offset:1024 sc1 lds
    v_exp_f32 v94, v94
    v_exp_f32 v95, v95
    s_add_u32 s55, s55, 140288
    v_exp_f32 v96, v96
    v_exp_f32 v97, v97
    v_smfmac_f32_32x32x32_bf16 v[112:127], v[24:27], v[88:95], v36
    v_exp_f32 v98, v98
    v_exp_f32 v99, v99
    buffer_load_dwordx4 v1, s[40:43], s53 offen offset:2048 sc1 lds
    v_exp_f32 v100, v100
    v_add_u32 v41, s55, v1
    s_waitcnt lgkmcnt(0)
    v_mfma_f32_32x32x16_bf16 v[80:95], v[16:19], v[4:7], v[48:63]
    v_exp_f32 v101, v101
    v_exp_f32 v102, v102
    v_exp_f32 v103, v103
    v_exp_f32 v104, v104
    v_exp_f32 v105, v105
    buffer_load_dwordx4 v1, s[40:43], s53 offen offset:3072 sc1 lds
    v_lshlrev_b32 v2, 2, v0
    v_exp_f32 v106, v106
    v_exp_f32 v107, v107
    v_smfmac_f32_32x32x32_bf16 v[128:143], v[20:23], v[96:103], v36
    v_exp_f32 v108, v108
    v_exp_f32 v109, v109
    v_exp_f32 v110, v110
    v_add_u32 v42, s55, v2
    v_exp_f32 v111, v111
    s_add_u32 m0, s1, 4096
    s_add_u32 s53, s9, 4096
    ds_read_b128 v[12:15], v37 offset:28672
    v_exp_f32 v80, v80
    v_exp_f32 v81, v81
    v_smfmac_f32_32x32x32_bf16 v[128:143], v[24:27], v[104:111], v36
    v_exp_f32 v82, v82
    v_exp_f32 v83, v83
    v_and_b32 v2, 12, v2
    v_exp_f32 v84, v84
    v_mfma_f32_32x32x16_bf16 v[96:111], v[16:19], v[8:11], v[64:79]
    s_mov_b64 exec, s[62:63]
    ds_read_b128 v[20:23], v37 offset:29696
    ds_read_b128 v[24:27], v37 offset:29952
    s_mov_b64 exec, -1
    v_exp_f32 v85, v85
    buffer_load_dwordx4 v1, s[40:43], s53 offen offset:0 sc1 lds
    v_exp_f32 v86, v86
    v_exp_f32 v87, v87
    v_exp_f32 v88, v88
    v_add_u32 v2, 139264, v2
    v_exp_f32 v89, v89
    v_exp_f32 v90, v90
    v_exp_f32 v91, v91
    buffer_load_dwordx4 v1, s[40:43], s53 offen offset:1024 sc1 lds
    v_smfmac_f32_32x32x32_bf16 v[112:127], v[28:31], v[80:87], v36
    v_exp_f32 v92, v92
    v_exp_f32 v93, v93
    s_lshl_b32 s54, s54, 2
    v_exp_f32 v94, v94
    v_exp_f32 v95, v95
    v_exp_f32 v96, v96
    v_exp_f32 v97, v97
    buffer_load_dwordx4 v1, s[40:43], s53 offen offset:2048 sc1 lds
    v_smfmac_f32_32x32x32_bf16 v[112:127], v[32:35], v[88:95], v36
    v_exp_f32 v98, v98
    s_add_u32 s54, s54, 139264
    v_exp_f32 v99, v99
    v_exp_f32 v100, v100
    s_waitcnt lgkmcnt(0)
    v_mfma_f32_32x32x16_bf16 v[80:95], v[12:15], v[4:7], v[48:63]
    v_exp_f32 v101, v101
    v_exp_f32 v102, v102
    v_exp_f32 v103, v103
    buffer_load_dwordx4 v1, s[40:43], s53 offen offset:3072 sc1 lds
    v_mov_b32 v43, s54
    v_exp_f32 v104, v104
    v_exp_f32 v105, v105
    v_exp_f32 v106, v106
    v_exp_f32 v107, v107
    v_smfmac_f32_32x32x32_bf16 v[128:143], v[28:31], v[96:103], v36
    v_exp_f32 v108, v108
    v_exp_f32 v109, v109
    v_exp_f32 v110, v110
    v_exp_f32 v111, v111
L_slot16:
    s_setprio 0
    s_cmp_eq_u32 s3, 0
    s_cbranch_scc1 L_last0
    ds_read_b128 v[16:19], v37 offset:30720
    v_exp_f32 v80, v80
    v_and_b32 v40, 31, v0
    v_exp_f32 v81, v81
    v_smfmac_f32_32x32x32_bf16 v[128:143], v[32:35], v[104:111], v36
    v_exp_f32 v82, v82
    v_lshlrev_b32 v40, 2, v40
    v_exp_f32 v83, v83
    v_exp_f32 v84, v84
    v_mfma_f32_32x32x16_bf16 v[96:111], v[12:15], v[8:11], v[64:79]
    s_mov_b64 exec, s[62:63]
    ds_read_b128 v[28:31], v37 offset:31744
    ds_read_b128 v[32:35], v37 offset:32000
    s_mov_b64 exec, -1
    v_exp_f32 v85, v85
    buffer_load_dword v252, v40, s[40:43], s0 offen sc1
    v_exp_f32 v86, v86
    v_exp_f32 v87, v87
    s_add_u32 s52, s11, 2097152
    s_add_u32 s53, s11, 2101248
    v_exp_f32 v88, v88
    v_exp_f32 v89, v89
    v_exp_f32 v90, v90
    buffer_load_dwordx4 v[208:211], v1, s[40:43], s52 offen offset:0 sc1
    v_exp_f32 v91, v91
    v_smfmac_f32_32x32x32_bf16 v[112:127], v[20:23], v[80:87], v36
    v_exp_f32 v92, v92
    buffer_load_dwordx4 v[212:215], v1, s[40:43], s52 offen offset:1024 sc1
    v_exp_f32 v93, v93
    v_exp_f32 v94, v94
    v_exp_f32 v95, v95
    buffer_load_dwordx4 v[216:219], v1, s[40:43], s52 offen offset:2048 sc1
    v_exp_f32 v96, v96
    v_exp_f32 v97, v97
    v_smfmac_f32_32x32x32_bf16 v[112:127], v[24:27], v[88:95], v36
    v_exp_f32 v98, v98
    buffer_load_dwordx4 v[220:223], v1, s[40:43], s52 offen offset:3072 sc1
    v_exp_f32 v99, v99
    v_exp_f32 v100, v100
    buffer_load_dwordx4 v[224:227], v1, s[40:43], s53 offen offset:0 sc1
    s_waitcnt lgkmcnt(0)
    v_mfma_f32_32x32x16_bf16 v[80:95], v[16:19], v[4:7], v[48:63]
    v_exp_f32 v101, v101
    v_exp_f32 v102, v102
    v_exp_f32 v103, v103
    buffer_load_dwordx4 v[228:231], v1, s[40:43], s53 offen offset:1024 sc1
    v_exp_f32 v104, v104
    v_exp_f32 v105, v105
    buffer_load_dwordx4 v[232:235], v1, s[40:43], s53 offen offset:2048 sc1
    v_exp_f32 v106, v106
    v_exp_f32 v107, v107
    v_smfmac_f32_32x32x32_bf16 v[128:143], v[20:23], v[96:103], v36
    v_exp_f32 v108, v108
    buffer_load_dwordx4 v[236:239], v1, s[40:43], s53 offen offset:3072 sc1
    v_exp_f32 v109, v109
    v_exp_f32 v110, v110
    v_exp_f32 v111, v111
    v_exp_f32 v80, v80
    v_exp_f32 v81, v81
    v_smfmac_f32_32x32x32_bf16 v[128:143], v[24:27], v[104:111], v36
    v_exp_f32 v82, v82
    v_exp_f32 v83, v83
    v_exp_f32 v84, v84
    v_mfma_f32_32x32x16_bf16 v[96:111], v[16:19], v[8:11], v[64:79]
    v_exp_f32 v85, v85
    v_exp_f32 v86, v86
    v_exp_f32 v87, v87
    v_exp_f32 v88, v88
    v_exp_f32 v89, v89
    v_exp_f32 v90, v90
    v_exp_f32 v91, v91
    v_smfmac_f32_32x32x32_bf16 v[112:127], v[28:31], v[80:87], v36
    v_exp_f32 v92, v92
    v_exp_f32 v93, v93
    v_exp_f32 v94, v94
    v_exp_f32 v95, v95
    v_exp_f32 v96, v96
    v_exp_f32 v97, v97
    v_smfmac_f32_32x32x32_bf16 v[112:127], v[32:35], v[88:95], v36
    v_exp_f32 v98, v98
    v_exp_f32 v99, v99
    v_exp_f32 v100, v100
    v_exp_f32 v101, v101
    v_exp_f32 v102, v102
    v_exp_f32 v103, v103
    v_exp_f32 v104, v104
    v_exp_f32 v105, v105
    v_exp_f32 v106, v106
    v_exp_f32 v107, v107
    v_smfmac_f32_32x32x32_bf16 v[128:143], v[28:31], v[96:103], v36
    v_exp_f32 v108, v108
    v_exp_f32 v109, v109
    v_exp_f32 v110, v110
    v_exp_f32 v111, v111
L_tail1:
    s_setprio 3
    s_nop 0
    v_smfmac_f32_32x32x32_bf16 v[128:143], v[32:35], v[104:111], v36
    ds_write_b128 v41, v[112:115]
    ds_write_b128 v41, v[116:119] offset:1024
    ds_write_b32 v42, v120 offset:4096
    s_nop 8
    ds_write_b128 v41, v[128:131] offset:2048
    ds_write_b128 v41, v[132:135] offset:3072
    ds_write_b32 v42, v136 offset:4352
    s_waitcnt lgkmcnt(0) vmcnt(9)
    s_barrier
    s_waitcnt vmcnt(0)
    s_branch L_join
.p2align 3
L_last0:
    ds_read_b128 v[16:19], v37 offset:30720
    v_exp_f32 v80, v80
    v_and_b32 v40, 31, v0
    v_exp_f32 v81, v81
    v_smfmac_f32_32x32x32_bf16 v[128:143], v[32:35], v[104:111], v36
    v_exp_f32 v82, v82
    v_lshlrev_b32 v40, 2, v40
    v_exp_f32 v83, v83
    v_exp_f32 v84, v84
    v_mfma_f32_32x32x16_bf16 v[96:111], v[12:15], v[8:11], v[64:79]
    s_mov_b64 exec, s[62:63]
    ds_read_b128 v[28:31], v37 offset:31744
    ds_read_b128 v[32:35], v37 offset:32000
    s_mov_b64 exec, -1
    v_exp_f32 v85, v85
    buffer_load_dword v252, v40, s[40:43], s0 offen sc1
    v_exp_f32 v86, v86
    v_exp_f32 v87, v87
    s_add_u32 s52, s11, 2097152
    s_add_u32 s53, s11, 2101248
    v_exp_f32 v88, v88
    v_exp_f32 v89, v89
    v_exp_f32 v90, v90
    buffer_load_dwordx4 v[208:211], v1, s[40:43], s52 offen offset:0 sc1
    v_exp_f32 v91, v91
    v_smfmac_f32_32x32x32_bf16 v[112:127], v[20:23], v[80:87], v36
    v_exp_f32 v92, v92
    buffer_load_dwordx4 v[212:215], v1, s[40:43], s52 offen offset:1024 sc1
    v_exp_f32 v93, v93
    v_exp_f32 v94, v94
    v_exp_f32 v95, v95
    buffer_load_dwordx4 v[216:219], v1, s[40:43], s52 offen offset:2048 sc1
    v_exp_f32 v96, v96
    v_exp_f32 v97, v97
    v_smfmac_f32_32x32x32_bf16 v[112:127], v[24:27], v[88:95], v36
    v_exp_f32 v98, v98
    buffer_load_dwordx4 v[220:223], v1, s[40:43], s52 offen offset:3072 sc1
    v_exp_f32 v99, v99
    v_exp_f32 v100, v100
    buffer_load_dwordx4 v[224:227], v1, s[40:43], s53 offen offset:0 sc1
    s_waitcnt lgkmcnt(0)
    v_mfma_f32_32x32x16_bf16 v[80:95], v[16:19], v[4:7], v[48:63]
    v_exp_f32 v101, v101
    v_exp_f32 v102, v102
    v_exp_f32 v103, v103
    buffer_load_dwordx4 v[228:231], v1, s[40:43], s53 offen offset:1024 sc1
    v_exp_f32 v104, v104
    v_exp_f32 v105, v105
    buffer_load_dwordx4 v[232:235], v1, s[40:43], s53 offen offset:2048 sc1
    v_exp_f32 v106, v106
    v_exp_f32 v107, v107
    v_smfmac_f32_32x32x32_bf16 v[128:143], v[20:23], v[96:103], v36
    v_exp_f32 v108, v108
    buffer_load_dwordx4 v[236:239], v1, s[40:43], s53 offen offset:3072 sc1
    v_exp_f32 v109, v109
    v_exp_f32 v110, v110
    v_exp_f32 v111, v111
    v_exp_f32 v80, v80
    v_exp_f32 v81, v81
    v_smfmac_f32_32x32x32_bf16 v[128:143], v[24:27], v[104:111], v36
    v_exp_f32 v82, v82
    v_exp_f32 v83, v83
    v_exp_f32 v84, v84
    v_mfma_f32_32x32x16_bf16 v[96:111], v[16:19], v[8:11], v[64:79]
    v_exp_f32 v85, v85
    v_exp_f32 v86, v86
    v_exp_f32 v87, v87
    v_exp_f32 v88, v88
    s_waitcnt vmcnt(9)
    s_barrier
    v_exp_f32 v89, v89
    v_exp_f32 v90, v90
    v_exp_f32 v91, v91
    v_smfmac_f32_32x32x32_bf16 v[112:127], v[28:31], v[80:87], v36
    v_exp_f32 v92, v92
    v_exp_f32 v93, v93
    v_exp_f32 v94, v94
    ds_read_b128 v[48:51], v41
    v_exp_f32 v95, v95
    ds_read_b128 v[52:55], v41 offset:1024
    v_exp_f32 v96, v96
    ds_read_b32 v56, v42 offset:4096
    v_exp_f32 v97, v97
    ds_read_b128 v[64:67], v41 offset:2048
    v_smfmac_f32_32x32x32_bf16 v[112:127], v[32:35], v[88:95], v36
    v_exp_f32 v98, v98
    ds_read_b128 v[68:71], v41 offset:3072
    v_exp_f32 v99, v99
    ds_read_b32 v72, v42 offset:4352
    v_exp_f32 v100, v100
    v_exp_f32 v101, v101
    v_exp_f32 v102, v102
    v_exp_f32 v103, v103
    v_exp_f32 v104, v104
    v_exp_f32 v105, v105
    v_exp_f32 v106, v106
    v_exp_f32 v107, v107
    v_smfmac_f32_32x32x32_bf16 v[128:143], v[28:31], v[96:103], v36
    v_exp_f32 v108, v108
    v_exp_f32 v109, v109
    v_exp_f32 v110, v110
    v_exp_f32 v111, v111
L_tail0:
    s_mov_b32 s52, 0x7e800000
    s_waitcnt lgkmcnt(0)
    v_smfmac_f32_32x32x32_bf16 v[128:143], v[32:35], v[104:111], v36
    s_add_u32 s53, s4, 32768
    s_mov_b32 s54, 0
    s_bitcmp1_b32 s65, 0
    v_add_f32 v120, v120, v56
    v_pk_add_f32 v[112:113], v[112:113], v[48:49]
    v_pk_add_f32 v[114:115], v[114:115], v[50:51]
    v_pk_add_f32 v[116:117], v[116:117], v[52:53]
    v_pk_add_f32 v[118:119], v[118:119], v[54:55]
    v_rcp_f32 v122, v120
    v_add_f32 v38, abs(v112), abs(v120)
    v_add_f32 v39, abs(v113), abs(v114)
    v_add_f32 v38, v38, abs(v115)
    v_add_f32 v39, v39, abs(v116)
    v_add_f32 v38, v38, abs(v117)
    v_add_f32 v39, v39, abs(v118)
    v_add_f32 v38, v38, abs(v119)
    v_add_f32 v38, v38, v39
    v_cmp_ngt_f32 vcc, s52, v38
    v_pk_mul_f32 v[112:113], v[112:113], v[122:123] op_sel_hi:[1,0]
    v_pk_mul_f32 v[114:115], v[114:115], v[122:123] op_sel_hi:[1,0]
    v_pk_mul_f32 v[116:117], v[116:117], v[122:123] op_sel_hi:[1,0]
    v_pk_mul_f32 v[118:119], v[118:119], v[122:123] op_sel_hi:[1,0]
    v_cvt_pk_bf16_f32 v240, v112, v113
    v_cvt_pk_bf16_f32 v241, v114, v115
    v_cvt_pk_bf16_f32 v242, v116, v117
    v_cvt_pk_bf16_f32 v243, v118, v119
    v_min_u32 v240, -2, v240
    v_min_u32 v241, -2, v241
    v_min_u32 v242, -2, v242
    v_min_u32 v243, -2, v243
    s_cbranch_scc1 L_ova_no
    s_cbranch_vccnz L_ova
L_ova_st:
    buffer_store_dwordx4 v[240:243], v1, s[40:43], s4 offen sc1
L_ova_no:
    s_bitcmp1_b32 s65, 1
    v_add_f32 v136, v136, v72
    v_pk_add_f32 v[128:129], v[128:129], v[64:65]
    v_pk_add_f32 v[130:131], v[130:131], v[66:67]
    v_pk_add_f32 v[132:133], v[132:133], v[68:69]
    v_pk_add_f32 v[134:135], v[134:135], v[70:71]
    v_rcp_f32 v138, v136
    v_add_f32 v38, abs(v128), abs(v136)
    v_add_f32 v39, abs(v129), abs(v130)
    v_add_f32 v38, v38, abs(v131)
    v_add_f32 v39, v39, abs(v132)
    v_add_f32 v38, v38, abs(v133)
    v_add_f32 v39, v39, abs(v134)
    v_add_f32 v38, v38, abs(v135)
    v_add_f32 v38, v38, v39
    v_cmp_ngt_f32 vcc, s52, v38
    v_pk_mul_f32 v[128:129], v[128:129], v[138:139] op_sel_hi:[1,0]
    v_pk_mul_f32 v[130:131], v[130:131], v[138:139] op_sel_hi:[1,0]
    v_pk_mul_f32 v[132:133], v[132:133], v[138:139] op_sel_hi:[1,0]
    v_pk_mul_f32 v[134:135], v[134:135], v[138:139] op_sel_hi:[1,0]
    v_cvt_pk_bf16_f32 v244, v128, v129
    v_cvt_pk_bf16_f32 v245, v130, v131
    v_cvt_pk_bf16_f32 v246, v132, v133
    v_cvt_pk_bf16_f32 v247, v134, v135
    v_min_u32 v244, -2, v244
    v_min_u32 v245, -2, v245
    v_min_u32 v246, -2, v246
    v_min_u32 v247, -2, v247
    s_cbranch_scc1 L_ovb_no
    s_cbranch_vccnz L_ovb
L_ovb_st:
    buffer_store_dwordx4 v[244:247], v1, s[40:43], s53 offen sc1
L_ovb_no:
    v_mov_b32 v45, s54
    ds_write_b32 v43, v45
    s_waitcnt lgkmcnt(0) vmcnt(2)
L_join:
    s_barrier
    ds_read_b32 v45, v2
    s_setprio 0
    s_waitcnt lgkmcnt(0)
    v_cmp_ne_u32 vcc, 0, v45
    s_nop 4
    s_cbranch_vccnz L_slow
    s_mov_b32 s59, 0
    s_add_u32 s54, s11, 4096
L_obchk:
    v_max3_u32 v40, v208, v209, v210
    v_max3_u32 v41, v211, v212, v213
    v_max3_u32 v40, v40, v214, v215
    v_max3_u32 v41, v41, v216, v217
    v_max3_u32 v40, v40, v218, v219
    v_max3_u32 v41, v41, v220, v221
    v_max3_u32 v40, v40, v222, v223
    v_max3_u32 v41, v41, v224, v225
    v_max3_u32 v40, v40, v226, v227
    v_max3_u32 v41, v41, v228, v229
    v_max3_u32 v40, v40, v230, v231
    v_max3_u32 v41, v41, v232, v233
    v_max3_u32 v40, v40, v234, v235
    v_max3_u32 v41, v41, v236, v237
    v_max3_u32 v40, v40, v238, v239
    v_max_u32 v40, v40, v41
    v_cmp_eq_u32 vcc, -1, v40
    s_bfe_u32 s52, s48, 0x10001
    s_lshl_b32 s52, s52, 14
    s_lshr_b32 s53, s48, 2
    s_mul_i32 s53, s53, 69632
    s_add_u32 s52, s52, s53
    v_add_u32 v39, s52, v1
    s_cbranch_vccnz L_obretry
L_obok:
    v_mfma_f32_32x32x16_bf16 v[48:63], v[144:147], v[208:211], 0
    ds_read_b128 v[144:147], v39 offset:0
    v_and_b32 v12, 31, v0
    v_lshrrev_b32 v13, 5, v0
    s_lshl_b32 s52, s48, 13
    v_mfma_f32_32x32x16_bf16 v[64:79], v[148:151], v[208:211], 0
    ds_read_b128 v[148:151], v39 offset:1024
    v_lshlrev_b32 v4, 8, v12
    v_add_u32 v4, s52, v4
    v_and_b32 v14, 7, v0
    v_mfma_f32_32x32x16_bf16 v[48:63], v[152:155], v[212:215], v[48:63]
    ds_read_b128 v[152:155], v39 offset:2048
    v_lshlrev_b32 v15, 2, v13
    v_xor_b32 v14, v14, v15
    v_lshl_add_u32 v4, v14, 4, v4
    v_mfma_f32_32x32x16_bf16 v[64:79], v[156:159], v[212:215], v[64:79]
    ds_read_b128 v[156:159], v39 offset:3072
    v_xor_b32 v5, 16, v4
    v_xor_b32 v6, 32, v4
    v_xor_b32 v7, 48, v4
    v_mfma_f32_32x32x16_bf16 v[48:63], v[160:163], v[216:219], v[48:63]
    ds_read_b128 v[160:163], v39 offset:4096
    v_lshrrev_b32 v14, 3, v0
    v_and_b32 v15, 7, v0
    v_lshlrev_b32 v8, 1, v15
    v_mfma_f32_32x32x16_bf16 v[64:79], v[164:167], v[216:219], v[64:79]
    ds_read_b128 v[164:167], v39 offset:5120
    v_xor_b32 v8, v8, v14
    v_lshlrev_b32 v8, 4, v8
    v_lshl_add_u32 v8, v14, 8, v8
    v_mfma_f32_32x32x16_bf16 v[48:63], v[168:171], v[220:223], v[48:63]
    ds_read_b128 v[168:171], v39 offset:6144
    s_lshl_b32 s52, s48, 11
    v_add_u32 v8, s52, v8
    v_xor_b32 v9, 16, v8
    v_mfma_f32_32x32x16_bf16 v[64:79], v[172:175], v[220:223], v[64:79]
    ds_read_b128 v[172:175], v39 offset:7168
    v_lshlrev_b32 v10, 10, v14
    v_lshl_add_u32 v10, v15, 4, v10
    s_and_b32 s52, s2, 31
    v_mfma_f32_32x32x16_bf16 v[48:63], v[176:179], v[224:227], v[48:63]
    ds_read_b128 v[176:179], v39 offset:8192
    buffer_load_dwordx4 v[80:83], v1, s[40:43], s11 offen offset:0 sc1
    s_lshl_b32 s52, s52, 16
    s_lshl_b32 s53, s48, 13
    s_add_u32 s52, s52, s53
    v_mfma_f32_32x32x16_bf16 v[64:79], v[180:183], v[224:227], v[64:79]
    ds_read_b128 v[180:183], v39 offset:9216
    buffer_load_dwordx4 v[84:87], v1, s[40:43], s11 offen offset:1024 sc1
    s_lshr_b32 s53, s2, 5
    s_lshl_b32 s53, s53, 7
    s_add_u32 s52, s52, s53
    v_mfma_f32_32x32x16_bf16 v[48:63], v[184:187], v[228:231], v[48:63]
    ds_read_b128 v[184:187], v39 offset:10240
    buffer_load_dwordx4 v[88:91], v1, s[40:43], s11 offen offset:2048 sc1
    v_sub_f32 v38, 1.0, v252
    s_mov_b32 s28, s20
    s_mov_b32 s29, s21
    v_mfma_f32_32x32x16_bf16 v[64:79], v[188:191], v[228:231], v[64:79]
    ds_read_b128 v[188:191], v39 offset:11264
    buffer_load_dwordx4 v[92:95], v1, s[40:43], s11 offen offset:3072 sc1
    s_mov_b32 s30, 2097152
    s_mov_b32 s31, 0x20000
    v_mfma_f32_32x32x16_bf16 v[48:63], v[192:195], v[232:235], v[48:63]
    ds_read_b128 v[192:195], v39 offset:12288
    buffer_load_dwordx4 v[96:99], v1, s[40:43], s54 offen offset:0 sc1
    v_mfma_f32_32x32x16_bf16 v[64:79], v[196:199], v[232:235], v[64:79]
    ds_read_b128 v[196:199], v39 offset:13312
    buffer_load_dwordx4 v[100:103], v1, s[40:43], s54 offen offset:1024 sc1
    v_mfma_f32_32x32x16_bf16 v[48:63], v[200:203], v[236:239], v[48:63]
    ds_read_b128 v[200:203], v39 offset:14336
    buffer_load_dwordx4 v[104:107], v1, s[40:43], s54 offen offset:2048 sc1
    v_mfma_f32_32x32x16_bf16 v[64:79], v[204:207], v[236:239], v[64:79]
    ds_read_b128 v[204:207], v39 offset:15360
    buffer_load_dwordx4 v[108:111], v1, s[40:43], s54 offen offset:3072 sc1
    s_nop 11
    v_pk_mul_f32 v[48:49], v[48:49], v[38:39] op_sel_hi:[1,0]
    v_pk_mul_f32 v[50:51], v[50:51], v[38:39] op_sel_hi:[1,0]
    v_pk_mul_f32 v[52:53], v[52:53], v[38:39] op_sel_hi:[1,0]
    v_pk_mul_f32 v[54:55], v[54:55], v[38:39] op_sel_hi:[1,0]
    v_pk_mul_f32 v[56:57], v[56:57], v[38:39] op_sel_hi:[1,0]
    v_pk_mul_f32 v[58:59], v[58:59], v[38:39] op_sel_hi:[1,0]
    v_pk_mul_f32 v[60:61], v[60:61], v[38:39] op_sel_hi:[1,0]
    v_pk_mul_f32 v[62:63], v[62:63], v[38:39] op_sel_hi:[1,0]
    v_pk_mul_f32 v[64:65], v[64:65], v[38:39] op_sel_hi:[1,0]
    v_pk_mul_f32 v[66:67], v[66:67], v[38:39] op_sel_hi:[1,0]
    v_pk_mul_f32 v[68:69], v[68:69], v[38:39] op_sel_hi:[1,0]
    v_pk_mul_f32 v[70:71], v[70:71], v[38:39] op_sel_hi:[1,0]
    v_pk_mul_f32 v[72:73], v[72:73], v[38:39] op_sel_hi:[1,0]
    v_pk_mul_f32 v[74:75], v[74:75], v[38:39] op_sel_hi:[1,0]
    v_pk_mul_f32 v[76:77], v[76:77], v[38:39] op_sel_hi:[1,0]
    v_pk_mul_f32 v[78:79], v[78:79], v[38:39] op_sel_hi:[1,0]
    s_waitcnt lgkmcnt(0)
    s_barrier
L_cons0:
    s_waitcnt vmcnt(7)
    v_max3_u32 v38, v80, v81, v82
    v_max_u32 v38, v38, v83
    v_cmp_eq_u32 vcc, -1, v38
    s_nop 4
    s_cbranch_vccnz L_retry0
L_go0:
    v_mfma_f32_32x32x16_bf16 v[112:127], v[144:147], v[80:83], 0
    v_mfma_f32_32x32x16_bf16 v[128:143], v[148:151], v[80:83], 0
L_cons1:
    s_waitcnt vmcnt(6)
    v_max3_u32 v38, v84, v85, v86
    v_max_u32 v38, v38, v87
    v_cmp_eq_u32 vcc, -1, v38
    s_nop 4
    s_cbranch_vccnz L_retry1
L_go1:
    v_mfma_f32_32x32x16_bf16 v[112:127], v[152:155], v[84:87], v[112:127]
    v_mfma_f32_32x32x16_bf16 v[128:143], v[156:159], v[84:87], v[128:143]
L_cons2:
    s_waitcnt vmcnt(5)
    v_max3_u32 v38, v88, v89, v90
    v_max_u32 v38, v38, v91
    v_cmp_eq_u32 vcc, -1, v38
    s_nop 4
    s_cbranch_vccnz L_retry2
L_go2:
    v_mfma_f32_32x32x16_bf16 v[112:127], v[160:163], v[88:91], v[112:127]
    v_mfma_f32_32x32x16_bf16 v[128:143], v[164:167], v[88:91], v[128:143]
L_cons3:
    s_waitcnt vmcnt(4)
    v_max3_u32 v38, v92, v93, v94
    v_max_u32 v38, v38, v95
    v_cmp_eq_u32 vcc, -1, v38
    s_nop 4
    s_cbranch_vccnz L_retry3
L_go3:
    v_mfma_f32_32x32x16_bf16 v[112:127], v[168:171], v[92:95], v[112:127]
    v_mfma_f32_32x32x16_bf16 v[128:143], v[172:175], v[92:95], v[128:143]
L_cons4:
    s_waitcnt vmcnt(3)
    v_max3_u32 v38, v96, v97, v98
    v_max_u32 v38, v38, v99
    v_cmp_eq_u32 vcc, -1, v38
    s_nop 4
    s_cbranch_vccnz L_retry4
L_go4:
    v_mfma_f32_32x32x16_bf16 v[112:127], v[176:179], v[96:99], v[112:127]
    v_mfma_f32_32x32x16_bf16 v[128:143], v[180:183], v[96:99], v[128:143]
L_cons5:
    s_waitcnt vmcnt(2)
    v_max3_u32 v38, v100, v101, v102
    v_max_u32 v38, v38, v103
    v_cmp_eq_u32 vcc, -1, v38
    s_nop 4
    s_cbranch_vccnz L_retry5
L_go5:
    v_mfma_f32_32x32x16_bf16 v[112:127], v[184:187], v[100:103], v[112:127]
    v_mfma_f32_32x32x16_bf16 v[128:143], v[188:191], v[100:103], v[128:143]
L_cons6:
    s_waitcnt vmcnt(1)
    v_max3_u32 v38, v104, v105, v106
    v_max_u32 v38, v38, v107
    v_cmp_eq_u32 vcc, -1, v38
    s_nop 4
    s_cbranch_vccnz L_retry6
L_go6:
    v_mfma_f32_32x32x16_bf16 v[112:127], v[192:195], v[104:107], v[112:127]
    v_mfma_f32_32x32x16_bf16 v[128:143], v[196:199], v[104:107], v[128:143]
L_cons7:
    s_waitcnt vmcnt(0)
    v_max3_u32 v38, v108, v109, v110
    v_max_u32 v38, v38, v111
    v_cmp_eq_u32 vcc, -1, v38
    s_nop 4
    s_cbranch_vccnz L_retry7
L_go7:
    v_mfma_f32_32x32x16_bf16 v[112:127], v[200:203], v[108:111], v[112:127]
    v_mfma_f32_32x32x16_bf16 v[128:143], v[204:207], v[108:111], v[128:143]
    s_nop 10
    v_pk_fma_f32 v[112:113], v[112:113], v[252:253], v[48:49] op_sel_hi:[1,0,1]
    v_pk_fma_f32 v[114:115], v[114:115], v[252:253], v[50:51] op_sel_hi:[1,0,1]
    v_pk_fma_f32 v[116:117], v[116:117], v[252:253], v[52:53] op_sel_hi:[1,0,1]
    v_pk_fma_f32 v[118:119], v[118:119], v[252:253], v[54:55] op_sel_hi:[1,0,1]
    v_pk_fma_f32 v[120:121], v[120:121], v[252:253], v[56:57] op_sel_hi:[1,0,1]
    v_pk_fma_f32 v[122:123], v[122:123], v[252:253], v[58:59] op_sel_hi:[1,0,1]
    v_pk_fma_f32 v[124:125], v[124:125], v[252:253], v[60:61] op_sel_hi:[1,0,1]
    v_pk_fma_f32 v[126:127], v[126:127], v[252:253], v[62:63] op_sel_hi:[1,0,1]
    ds_write_b128 v4, v[112:115] offset:0
    ds_write_b128 v5, v[116:119] offset:0
    ds_write_b128 v6, v[120:123] offset:0
    ds_write_b128 v7, v[124:127] offset:0
    v_pk_fma_f32 v[128:129], v[128:129], v[252:253], v[64:65] op_sel_hi:[1,0,1]
    v_pk_fma_f32 v[130:131], v[130:131], v[252:253], v[66:67] op_sel_hi:[1,0,1]
    v_pk_fma_f32 v[132:133], v[132:133], v[252:253], v[68:69] op_sel_hi:[1,0,1]
    v_pk_fma_f32 v[134:135], v[134:135], v[252:253], v[70:71] op_sel_hi:[1,0,1]
    v_pk_fma_f32 v[136:137], v[136:137], v[252:253], v[72:73] op_sel_hi:[1,0,1]
    v_pk_fma_f32 v[138:139], v[138:139], v[252:253], v[74:75] op_sel_hi:[1,0,1]
    v_pk_fma_f32 v[140:141], v[140:141], v[252:253], v[76:77] op_sel_hi:[1,0,1]
    v_pk_fma_f32 v[142:143], v[142:143], v[252:253], v[78:79] op_sel_hi:[1,0,1]
    ds_write_b128 v4, v[128:131] offset:128
    ds_write_b128 v5, v[132:135] offset:128
    ds_write_b128 v6, v[136:139] offset:128
    ds_write_b128 v7, v[140:143] offset:128
    s_waitcnt lgkmcnt(0)
    s_barrier
    ds_read_b128 v[16:19], v8 offset:0
    ds_read_b128 v[20:23], v9 offset:0
    ds_read_b128 v[24:27], v8 offset:16384
    ds_read_b128 v[28:31], v9 offset:16384
    ds_read_b128 v[32:35], v8 offset:32768
    ds_read_b128 v[36:39], v9 offset:32768
    ds_read_b128 v[40:43], v8 offset:49152
    ds_read_b128 v[44:47], v9 offset:49152
    s_waitcnt lgkmcnt(4)
    v_pk_add_f32 v[16:17], v[16:17], v[24:25]
    v_pk_add_f32 v[18:19], v[18:19], v[26:27]
    v_pk_add_f32 v[20:21], v[20:21], v[28:29]
    v_pk_add_f32 v[22:23], v[22:23], v[30:31]
    s_waitcnt lgkmcnt(2)
    v_pk_add_f32 v[16:17], v[16:17], v[32:33]
    v_pk_add_f32 v[18:19], v[18:19], v[34:35]
    v_pk_add_f32 v[20:21], v[20:21], v[36:37]
    v_pk_add_f32 v[22:23], v[22:23], v[38:39]
    s_waitcnt lgkmcnt(0)
    v_pk_add_f32 v[16:17], v[16:17], v[40:41]
    v_pk_add_f32 v[18:19], v[18:19], v[42:43]
    v_pk_add_f32 v[20:21], v[20:21], v[44:45]
    v_pk_add_f32 v[22:23], v[22:23], v[46:47]
    v_cvt_pk_bf16_f32 v16, v16, v17
    v_cvt_pk_bf16_f32 v17, v18, v19
    v_cvt_pk_bf16_f32 v18, v20, v21
    v_cvt_pk_bf16_f32 v19, v22, v23
    buffer_store_dwordx4 v[16:19], v10, s[28:31], s52 offen sc1
L_end:
    s_endpgm
L_retry0:
    s_add_u32 s59, s59, 1
    s_cmp_ge_u32 s59, 400000
    s_cbranch_scc1 L_go0
    buffer_load_dwordx4 v[80:83], v1, s[40:43], s11 offen offset:0 sc1
    buffer_load_dwordx4 v[84:87], v1, s[40:43], s11 offen offset:1024 sc1
    buffer_load_dwordx4 v[88:91], v1, s[40:43], s11 offen offset:2048 sc1
    buffer_load_dwordx4 v[92:95], v1, s[40:43], s11 offen offset:3072 sc1
    buffer_load_dwordx4 v[96:99], v1, s[40:43], s54 offen offset:0 sc1
    buffer_load_dwordx4 v[100:103], v1, s[40:43], s54 offen offset:1024 sc1
    buffer_load_dwordx4 v[104:107], v1, s[40:43], s54 offen offset:2048 sc1
    buffer_load_dwordx4 v[108:111], v1, s[40:43], s54 offen offset:3072 sc1
    s_branch L_cons0
L_retry1:
    s_add_u32 s59, s59, 1
    s_cmp_ge_u32 s59, 400000
    s_cbranch_scc1 L_go1
    buffer_load_dwordx4 v[84:87], v1, s[40:43], s11 offen offset:1024 sc1
    buffer_load_dwordx4 v[88:91], v1, s[40:43], s11 offen offset:2048 sc1
    buffer_load_dwordx4 v[92:95], v1, s[40:43], s11 offen offset:3072 sc1
    buffer_load_dwordx4 v[96:99], v1, s[40:43], s54 offen offset:0 sc1
    buffer_load_dwordx4 v[100:103], v1, s[40:43], s54 offen offset:1024 sc1
    buffer_load_dwordx4 v[104:107], v1, s[40:43], s54 offen offset:2048 sc1
    buffer_load_dwordx4 v[108:111], v1, s[40:43], s54 offen offset:3072 sc1
    s_branch L_cons1
L_retry2:
    s_add_u32 s59, s59, 1
    s_cmp_ge_u32 s59, 400000
    s_cbranch_scc1 L_go2
    buffer_load_dwordx4 v[88:91], v1, s[40:43], s11 offen offset:2048 sc1
    buffer_load_dwordx4 v[92:95], v1, s[40:43], s11 offen offset:3072 sc1
    buffer_load_dwordx4 v[96:99], v1, s[40:43], s54 offen offset:0 sc1
    buffer_load_dwordx4 v[100:103], v1, s[40:43], s54 offen offset:1024 sc1
    buffer_load_dwordx4 v[104:107], v1, s[40:43], s54 offen offset:2048 sc1
    buffer_load_dwordx4 v[108:111], v1, s[40:43], s54 offen offset:3072 sc1
    s_branch L_cons2
L_retry3:
    s_add_u32 s59, s59, 1
    s_cmp_ge_u32 s59, 400000
    s_cbranch_scc1 L_go3
    buffer_load_dwordx4 v[92:95], v1, s[40:43], s11 offen offset:3072 sc1
    buffer_load_dwordx4 v[96:99], v1, s[40:43], s54 offen offset:0 sc1
    buffer_load_dwordx4 v[100:103], v1, s[40:43], s54 offen offset:1024 sc1
    buffer_load_dwordx4 v[104:107], v1, s[40:43], s54 offen offset:2048 sc1
    buffer_load_dwordx4 v[108:111], v1, s[40:43], s54 offen offset:3072 sc1
    s_branch L_cons3
L_retry4:
    s_add_u32 s59, s59, 1
    s_cmp_ge_u32 s59, 400000
    s_cbranch_scc1 L_go4
    buffer_load_dwordx4 v[96:99], v1, s[40:43], s54 offen offset:0 sc1
    buffer_load_dwordx4 v[100:103], v1, s[40:43], s54 offen offset:1024 sc1
    buffer_load_dwordx4 v[104:107], v1, s[40:43], s54 offen offset:2048 sc1
    buffer_load_dwordx4 v[108:111], v1, s[40:43], s54 offen offset:3072 sc1
    s_branch L_cons4
L_retry5:
    s_add_u32 s59, s59, 1
    s_cmp_ge_u32 s59, 400000
    s_cbranch_scc1 L_go5
    buffer_load_dwordx4 v[100:103], v1, s[40:43], s54 offen offset:1024 sc1
    buffer_load_dwordx4 v[104:107], v1, s[40:43], s54 offen offset:2048 sc1
    buffer_load_dwordx4 v[108:111], v1, s[40:43], s54 offen offset:3072 sc1
    s_branch L_cons5
L_retry6:
    s_add_u32 s59, s59, 1
    s_cmp_ge_u32 s59, 400000
    s_cbranch_scc1 L_go6
    buffer_load_dwordx4 v[104:107], v1, s[40:43], s54 offen offset:2048 sc1
    buffer_load_dwordx4 v[108:111], v1, s[40:43], s54 offen offset:3072 sc1
    s_branch L_cons6
L_retry7:
    s_add_u32 s59, s59, 1
    s_cmp_ge_u32 s59, 400000
    s_cbranch_scc1 L_go7
    buffer_load_dwordx4 v[108:111], v1, s[40:43], s54 offen offset:3072 sc1
    s_branch L_cons7
L_ova:
    s_cmp_lg_u32 s65, 0
    s_cbranch_scc1 L_ova_st
    s_bitset1_b32 s54, 0
    s_branch L_ova_no
L_ovb:
    s_cmp_lg_u32 s65, 0
    s_cbranch_scc1 L_ovb_st
    s_bitset1_b32 s54, 1
    s_branch L_ovb_no
L_obretry:
    s_add_u32 s59, s59, 1
    s_cmp_ge_u32 s59, 400000
    s_cbranch_scc1 L_obok
    s_add_u32 s52, s11, 2097152
    s_add_u32 s53, s11, 2101248
    buffer_load_dwordx4 v[208:211], v1, s[40:43], s52 offen offset:0 sc1
    buffer_load_dwordx4 v[212:215], v1, s[40:43], s52 offen offset:1024 sc1
    buffer_load_dwordx4 v[216:219], v1, s[40:43], s52 offen offset:2048 sc1
    buffer_load_dwordx4 v[220:223], v1, s[40:43], s52 offen offset:3072 sc1
    buffer_load_dwordx4 v[224:227], v1, s[40:43], s53 offen offset:0 sc1
    buffer_load_dwordx4 v[228:231], v1, s[40:43], s53 offen offset:1024 sc1
    buffer_load_dwordx4 v[232:235], v1, s[40:43], s53 offen offset:2048 sc1
    buffer_load_dwordx4 v[236:239], v1, s[40:43], s53 offen offset:3072 sc1
    s_waitcnt vmcnt(0)
    s_branch L_obchk
L_pollF1:
    s_sleep 2
    buffer_load_dword v40, v41, s[40:43], s52 offen sc1
    s_add_u32 s59, s59, 1
    s_waitcnt vmcnt(0)
    v_cmp_gt_u32 vcc, 16, v40
    s_cmp_ge_u32 s59, 400000
    s_cbranch_scc1 L_pollF1_ok
    s_nop 2
    s_cbranch_vccnz L_pollF1
    s_branch L_pollF1_ok
L_mbox:
    ds_read_b32 v40, v154
    s_add_u32 s59, s59, 1
    s_waitcnt lgkmcnt(0)
    v_readfirstlane_b32 s58, v40
    s_cmp_lg_u32 s58, 0
    s_cbranch_scc1 L_mbox_ok
    s_sleep 1
    s_cmp_lt_u32 s59, 3200000
    s_cbranch_scc1 L_mbox
    s_branch L_mbox_ok
L_sig1:
    s_mov_b32 s59, 0
L_initpoll:
    s_sleep 4
    global_load_dword v10, v3, s[22:23] sc1
    s_add_u32 s59, s59, 1
    s_waitcnt vmcnt(0)
    v_readfirstlane_b32 s58, v10
    s_cmp_lg_u32 s58, 0
    s_cbranch_scc1 L_initdone
    s_cmp_lt_u32 s59, 400000
    s_cbranch_scc1 L_initpoll
L_initdone:
    s_bitcmp1_b32 s2, 5
    s_cbranch_scc1 L_initok1
    s_branch L_initok0
L_flagspin:
    s_mov_b32 s59, 0
L_flagspin2:
    s_sleep 16
    buffer_load_dword v41, v3, s[40:43], s5 offen sc1
    s_add_u32 s59, s59, 1
    s_waitcnt vmcnt(0)
    v_readfirstlane_b32 s58, v41
    s_cmp_ge_u32 s58, 32
    s_cbranch_scc1 L_flagok
    s_cmp_lt_u32 s59, 400000
    s_cbranch_scc1 L_flagspin2
    s_branch L_flagok
L_flag2spin:
    s_mov_b32 s59, 0
L_flag2spin2:
    s_sleep 32
    buffer_load_dword v41, v42, s[40:43], s57 offen sc1
    s_add_u32 s59, s59, 1
    s_waitcnt vmcnt(0)
    v_cmp_gt_u32 vcc, 32, v41
    s_cmp_ge_u32 s59, 400000
    s_cbranch_scc1 L_flag2ok
    s_nop 2
    s_cbranch_vccnz L_flag2spin2
    s_branch L_flag2ok
L_ktspin:
    s_mov_b32 s59, 0
L_ktspin2:
    s_sleep 8
    buffer_load_dwordx4 v[208:211], v1, s[40:43], s7 offen sc1
    buffer_load_dwordx4 v[212:215], v1, s[40:43], s7 offen offset:1024 sc1
    s_add_u32 s59, s59, 1
    s_waitcnt vmcnt(0)
    v_max3_u32 v40, v208, v209, v210
    v_max3_u32 v41, v211, v212, v213
    v_max3_u32 v40, v40, v214, v215
    v_max_u32 v40, v40, v41
    v_cmp_eq_u32 vcc, -1, v40
    s_cmp_ge_u32 s59, 400000
    s_cbranch_scc1 L_ktok
    s_nop 2
    s_cbranch_vccnz L_ktspin2
    s_branch L_ktok
L_slow:
    s_barrier
    s_and_b32 s65, s54, 3
    s_xor_b32 s65, s65, 7
    s_lshl_b32 s53, s26, 17
    s_add_u32 s53, s53, 2097152
    s_add_u32 s53, s53, s1
    s_add_u32 m0, s1, 0
    s_add_u32 s53, s53, 0
    buffer_load_dwordx4 v1, s[40:43], s53 offen offset:0 sc1 lds
    buffer_load_dwordx4 v1, s[40:43], s53 offen offset:1024 sc1 lds
    buffer_load_dwordx4 v1, s[40:43], s53 offen offset:2048 sc1 lds
    buffer_load_dwordx4 v1, s[40:43], s53 offen offset:3072 sc1 lds
    s_add_u32 m0, s1, 4096
    s_add_u32 s53, s53, 4096
    buffer_load_dwordx4 v1, s[40:43], s53 offen offset:0 sc1 lds
    buffer_load_dwordx4 v1, s[40:43], s53 offen offset:1024 sc1 lds
    buffer_load_dwordx4 v1, s[40:43], s53 offen offset:2048 sc1 lds
    buffer_load_dwordx4 v1, s[40:43], s53 offen offset:3072 sc1 lds
    s_mov_b32 s64, 0
    v_mov_b32 v37, v1
    v_mov_b32 v38, 0xff800000
    v_mov_b32 v39, 0xff800000
    v_mov_b32 v47, v41
    s_waitcnt vmcnt(0)
    s_barrier
L_mloop:
    ds_read_b128 v[12:15], v37
    s_waitcnt lgkmcnt(0)
    v_mfma_f32_32x32x16_bf16 v[80:95], v[12:15], v[4:7], 0
    v_mfma_f32_32x32x16_bf16 v[96:111], v[12:15], v[8:11], 0
    s_nop 15
    v_max3_f32 v38, v38, v80, v81
    v_max3_f32 v39, v39, v96, v97
    v_max3_f32 v38, v38, v82, v83
    v_max3_f32 v39, v39, v98, v99
    v_max3_f32 v38, v38, v84, v85
    v_max3_f32 v39, v39, v100, v101
    v_max3_f32 v38, v38, v86, v87
    v_max3_f32 v39, v39, v102, v103
    v_max3_f32 v38, v38, v88, v89
    v_max3_f32 v39, v39, v104, v105
    v_max3_f32 v38, v38, v90, v91
    v_max3_f32 v39, v39, v106, v107
    v_max3_f32 v38, v38, v92, v93
    v_max3_f32 v39, v39, v108, v109
    v_max3_f32 v38, v38, v94, v95
    v_max3_f32 v39, v39, v110, v111
    v_add_u32 v37, 2048, v37
    s_add_u32 s64, s64, 1
    s_cmp_lt_u32 s64, 64
    s_cbranch_scc1 L_mloop
    v_permlane32_swap_b32 v38, v39
    s_nop 1
    v_max_f32 v38, v38, v39
    v_sub_f32 v38, 0, v38
    v_mov_b32 v39, v38
    s_nop 1
    v_permlane32_swap_b32 v38, v39
    s_lshl_b32 s52, s3, 16
    v_add_u32 v37, s52, v1
    s_mov_b32 s64, 0
    ds_read_b128 v[12:15], v37
    s_mov_b64 exec, s[62:63]
    ds_read_b128 v[20:23], v37 offset:1024
    ds_read_b128 v[24:27], v37 offset:1280
    s_mov_b64 exec, -1
    v_mov_b32 v40, v38
    v_mov_b32 v41, v38
    v_mov_b64 v[48:49], v[40:41]
    v_mov_b64 v[50:51], v[40:41]
    v_mov_b64 v[52:53], v[40:41]
    v_mov_b64 v[54:55], v[40:41]
    v_mov_b64 v[56:57], v[40:41]
    v_mov_b64 v[58:59], v[40:41]
    v_mov_b64 v[60:61], v[40:41]
    v_mov_b64 v[62:63], v[40:41]
    v_mov_b32 v38, v39
    v_mov_b64 v[64:65], v[38:39]
    v_mov_b64 v[66:67], v[38:39]
    v_mov_b64 v[68:69], v[38:39]
    v_mov_b64 v[70:71], v[38:39]
    v_mov_b64 v[72:73], v[38:39]
    v_mov_b64 v[74:75], v[38:39]
    v_mov_b64 v[76:77], v[38:39]
    v_mov_b64 v[78:79], v[38:39]
    v_mov_b64 v[112:113], 0
    v_mov_b64 v[114:115], 0
    v_mov_b64 v[116:117], 0
    v_mov_b64 v[118:119], 0
    v_mov_b64 v[120:121], 0
    v_mov_b64 v[122:123], 0
    v_mov_b64 v[124:125], 0
    v_mov_b64 v[126:127], 0
    v_mov_b64 v[128:129], 0
    v_mov_b64 v[130:131], 0
    v_mov_b64 v[132:133], 0
    v_mov_b64 v[134:135], 0
    v_mov_b64 v[136:137], 0
    v_mov_b64 v[138:139], 0
    v_mov_b64 v[140:141], 0
    v_mov_b64 v[142:143], 0
    v_mov_b64 v[104:105], 0
    v_mov_b64 v[106:107], 0
    v_mov_b64 v[108:109], 0
    v_mov_b64 v[110:111], 0
    s_waitcnt lgkmcnt(0)
    v_mfma_f32_32x32x16_bf16 v[80:95], v[12:15], v[4:7], v[48:63]
    s_nop 15
L_sloop:
    ds_read_b128 v[16:19], v37 offset:2048
    v_exp_f32 v80, v80
    v_exp_f32 v81, v81
    v_smfmac_f32_32x32x32_bf16 v[128:143], v[32:35], v[104:111], v36
    v_exp_f32 v82, v82
    v_exp_f32 v83, v83
    v_exp_f32 v84, v84
    v_mfma_f32_32x32x16_bf16 v[96:111], v[12:15], v[8:11], v[64:79]
    s_mov_b64 exec, s[62:63]
    ds_read_b128 v[28:31], v37 offset:3072
    ds_read_b128 v[32:35], v37 offset:3328
    s_mov_b64 exec, -1
    v_exp_f32 v85, v85
    v_exp_f32 v86, v86
    v_exp_f32 v87, v87
    v_exp_f32 v88, v88
    v_exp_f32 v89, v89
    v_exp_f32 v90, v90
    v_exp_f32 v91, v91
    v_smfmac_f32_32x32x32_bf16 v[112:127], v[20:23], v[80:87], v36
    v_exp_f32 v92, v92
    v_exp_f32 v93, v93
    v_exp_f32 v94, v94
    v_exp_f32 v95, v95
    v_exp_f32 v96, v96
    v_exp_f32 v97, v97
    v_smfmac_f32_32x32x32_bf16 v[112:127], v[24:27], v[88:95], v36
    v_exp_f32 v98, v98
    v_exp_f32 v99, v99
    v_exp_f32 v100, v100
    s_waitcnt lgkmcnt(0)
    v_mfma_f32_32x32x16_bf16 v[80:95], v[16:19], v[4:7], v[48:63]
    v_exp_f32 v101, v101
    v_exp_f32 v102, v102
    v_exp_f32 v103, v103
    v_exp_f32 v104, v104
    v_exp_f32 v105, v105
    v_exp_f32 v106, v106
    v_exp_f32 v107, v107
    v_smfmac_f32_32x32x32_bf16 v[128:143], v[20:23], v[96:103], v36
    v_exp_f32 v108, v108
    v_exp_f32 v109, v109
    v_exp_f32 v110, v110
    v_exp_f32 v111, v111
    ds_read_b128 v[12:15], v37 offset:4096
    v_exp_f32 v80, v80
    v_exp_f32 v81, v81
    v_smfmac_f32_32x32x32_bf16 v[128:143], v[24:27], v[104:111], v36
    v_exp_f32 v82, v82
    v_exp_f32 v83, v83
    v_exp_f32 v84, v84
    v_mfma_f32_32x32x16_bf16 v[96:111], v[16:19], v[8:11], v[64:79]
    s_mov_b64 exec, s[62:63]
    ds_read_b128 v[20:23], v37 offset:5120
    ds_read_b128 v[24:27], v37 offset:5376
    s_mov_b64 exec, -1
    v_exp_f32 v85, v85
    v_exp_f32 v86, v86
    v_exp_f32 v87, v87
    v_exp_f32 v88, v88
    v_exp_f32 v89, v89
    v_exp_f32 v90, v90
    v_exp_f32 v91, v91
    v_smfmac_f32_32x32x32_bf16 v[112:127], v[28:31], v[80:87], v36
    v_exp_f32 v92, v92
    v_exp_f32 v93, v93
    v_exp_f32 v94, v94
    v_exp_f32 v95, v95
    v_exp_f32 v96, v96
    v_exp_f32 v97, v97
    v_smfmac_f32_32x32x32_bf16 v[112:127], v[32:35], v[88:95], v36
    v_exp_f32 v98, v98
    v_exp_f32 v99, v99
    v_exp_f32 v100, v100
    s_waitcnt lgkmcnt(0)
    v_mfma_f32_32x32x16_bf16 v[80:95], v[12:15], v[4:7], v[48:63]
    v_exp_f32 v101, v101
    v_exp_f32 v102, v102
    v_exp_f32 v103, v103
    v_exp_f32 v104, v104
    v_exp_f32 v105, v105
    v_exp_f32 v106, v106
    v_exp_f32 v107, v107
    v_smfmac_f32_32x32x32_bf16 v[128:143], v[28:31], v[96:103], v36
    v_exp_f32 v108, v108
    v_exp_f32 v109, v109
    v_exp_f32 v110, v110
    v_exp_f32 v111, v111
    v_add_u32 v37, 4096, v37
    s_add_u32 s64, s64, 1
    s_cmp_lt_u32 s64, 16
    s_cbranch_scc1 L_sloop
    v_mov_b32 v41, v47
    s_barrier
    s_add_u32 m0, s1, 0
    s_add_u32 s53, s9, 0
    buffer_load_dwordx4 v1, s[40:43], s53 offen offset:0 sc1 lds
    buffer_load_dwordx4 v1, s[40:43], s53 offen offset:1024 sc1 lds
    buffer_load_dwordx4 v1, s[40:43], s53 offen offset:2048 sc1 lds
    buffer_load_dwordx4 v1, s[40:43], s53 offen offset:3072 sc1 lds
    s_add_u32 m0, s1, 4096
    s_add_u32 s53, s9, 4096
    buffer_load_dwordx4 v1, s[40:43], s53 offen offset:0 sc1 lds
    buffer_load_dwordx4 v1, s[40:43], s53 offen offset:1024 sc1 lds
    buffer_load_dwordx4 v1, s[40:43], s53 offen offset:2048 sc1 lds
    buffer_load_dwordx4 v1, s[40:43], s53 offen offset:3072 sc1 lds
    s_waitcnt vmcnt(0)
    s_cmp_lg_u32 s3, 0
    s_cbranch_scc1 L_tail1
    s_barrier
    ds_read_b128 v[48:51], v41
    ds_read_b128 v[52:55], v41 offset:1024
    ds_read_b32 v56, v42 offset:4096
    ds_read_b128 v[64:67], v41 offset:2048
    ds_read_b128 v[68:71], v41 offset:3072
    ds_read_b32 v72, v42 offset:4352
    s_branch L_tail0
L_codeend:
    s_endpgm
.section .rodata,"a"
.p2align 6
.amdhsa_kernel gated_mix__mha_block__linear_kernel_hedgehog__prompt_kernel
  .amdhsa_next_free_vgpr 256
  .amdhsa_next_free_sgpr 102
  .amdhsa_accum_offset 256
  .amdhsa_group_segment_fixed_size 0
  .amdhsa_kernarg_size 88
  .amdhsa_user_sgpr_count 2
  .amdhsa_user_sgpr_kernarg_segment_ptr 1
  .amdhsa_system_sgpr_workgroup_id_x 1
.end_amdhsa_kernel
```
